```python
import torch

def _softmax(x, axis=-1):
    return torch.softmax(x, dim=axis)
def _gelu(x):
    return torch.nn.functional.gelu(x, approximate="tanh")
def _silu(x):
    return torch.nn.functional.silu(x)
def _sigmoid(x):
    return torch.sigmoid(x)
def _layernorm(x, axis=-1, eps=1e-5):
    m = x.mean(dim=axis, keepdim=True)
    v = x.var(dim=axis, keepdim=True, unbiased=False)
    return (x - m) / torch.sqrt(v + eps)
def _scatter_add(tgt, idx, src, axis=0):
    return tgt.clone().index_add_(axis, idx, src)
def _segment_sum(src, seg, n):
    out = torch.zeros((n,) + src.shape[1:], dtype=src.dtype)
    return out.index_add_(0, seg, src)
def _pad(x, pw):
    flat = tuple(v for pair in reversed(pw) for v in pair)
    return torch.nn.functional.pad(x, flat)

kernel_name = 'concat_heads__compressed_kv_cla__ssm_conv_s4__prompt'

def setup_inputs():

    _w = (lambda a: (lambda t: t.to(torch.bfloat16) if t.is_floating_point() else t)(torch.as_tensor(a)))
    def _A_setup():
        B, H, Sq, Sk, D, M = 1, 32, 2048, 2048, 128, 512
        Dc = 4 * D
        return {
            "x": _w((lambda *s: torch.randn(*s, dtype=torch.bfloat16) * 3.2)(B, Sq, M)),
            "c_kv": _w((lambda *s: torch.randn(*s, dtype=torch.bfloat16) * 0.1)(B, Sk, Dc)),
            "w_q": _w((lambda *s: torch.randn(*s, dtype=torch.bfloat16) * 6.4)(M, H, D) * (M ** -0.5)),
            "w_uk": _w((lambda *s: torch.randn(*s, dtype=torch.bfloat16) * 6.4)(Dc, H, D) * (Dc ** -0.5)),
            "w_uv": _w((lambda *s: torch.randn(*s, dtype=torch.bfloat16) * 0.1)(Dc, H, D) * (Dc ** -0.5)),
            "w_o": _w((lambda *s: torch.randn(*s, dtype=torch.bfloat16) * 0.1)(H, D, M) * ((H * D) ** -0.5)),
        }
    _A_in = _A_setup()

    def _B_setup():
        B, L, D, N = 1, 2048, 512, 128
        A_re = -(lambda _x: torch.exp(torch.as_tensor(_x)))((lambda *s: torch.randn(*s, dtype=torch.bfloat16) * 3.2)(D, N))
        A_im = torch.pi * (lambda *s: torch.randn(*s, dtype=torch.bfloat16) * 0.05)(D, N)
        B_re = (lambda *s: torch.randn(*s, dtype=torch.bfloat16) * 0.1)(D, N)
        B_im = (lambda *s: torch.randn(*s, dtype=torch.bfloat16) * 0.1)(D, N)
        C_re = (lambda *s: torch.randn(*s, dtype=torch.bfloat16) * 0.1)(D, N)
        C_im = (lambda *s: torch.randn(*s, dtype=torch.bfloat16) * 0.1)(D, N)
        log_dt = (lambda *s: torch.randn(*s, dtype=torch.bfloat16) * 0.05)(D) * 0.5 - 4.0
        Dskip = (lambda *s: torch.randn(*s, dtype=torch.bfloat16) * 0.05)(D)
        return {
            "u": _w((lambda *s: torch.randn(*s, dtype=torch.bfloat16) * 0.05)(B, L, D)),
            "A_re": _w(A_re),
            "A_im": _w(A_im),
            "B_re": _w(B_re),
            "B_im": _w(B_im),
            "C_re": _w(C_re),
            "C_im": _w(C_im),
            "log_dt": _w(log_dt),
            "Dskip": _w(Dskip),
        }
    _B_in = _B_setup()

    return {
        "A_x": _A_in["x"],
        "A_c_kv": _A_in["c_kv"],
        "A_w_q": _A_in["w_q"],
        "A_w_uk": _A_in["w_uk"],
        "A_w_uv": _A_in["w_uv"],
        "A_w_o": _A_in["w_o"],
        "B_u": _B_in["u"],
        "B_A_re": _B_in["A_re"],
        "B_A_im": _B_in["A_im"],
        "B_B_re": _B_in["B_re"],
        "B_B_im": _B_in["B_im"],
        "B_C_re": _B_in["C_re"],
        "B_C_im": _B_in["C_im"],
        "B_log_dt": _B_in["log_dt"],
        "B_Dskip": _B_in["Dskip"],
    }

def reference(A_x, A_c_kv, A_w_q, A_w_uk, A_w_uv, A_w_o, B_u, B_A_re, B_A_im, B_B_re, B_B_im, B_C_re, B_C_im, B_log_dt, B_Dskip):
    def _A_ref(x, c_kv, w_q, w_uk, w_uv, w_o):
        B, Sq, M = x.shape[0], x.shape[1], x.shape[2]
        Sk = c_kv.shape[1]
        H, D = w_q.shape[1], w_q.shape[2]
        q = torch.einsum("bqm,mhd->bhqd", x, w_q)
        k = torch.einsum("bkc,chd->bhkd", c_kv, w_uk)
        v = torch.einsum("bkc,chd->bhkd", c_kv, w_uv)
        scores = torch.einsum("bhqd,bhkd->bhqk", q, k) * (D ** -0.5)
        off = Sk - Sq
        qi = torch.arange(Sq)[:, None]
        kj = torch.arange(Sk)[None, :]
        cmask = kj <= (qi + off)
        scores = torch.where(cmask[None, None], scores, -1e9)
        p = _softmax(scores, axis=-1)
        ctx = torch.einsum("bhqk,bhkd->bhqd", p, v)
        return torch.einsum("bhqd,hdm->bqm", ctx, w_o)

    def _B_ref(u, A_re, A_im, B_re, B_im, C_re, C_im, log_dt, Dskip):
        Bsz, L, D = u.shape
        dt = torch.exp(log_dt)[:, None]
        A = A_re + 1j * A_im
        Bc = B_re + 1j * B_im
        Cc = C_re + 1j * C_im
        logdA = dt * A
        dB = dt * Bc
        l = (lambda x, dt: x.to(dt))(torch.arange(L), A_re.dtype)
        P = torch.exp(logdA[:, :, None] * l[None, None, :])
        K = torch.einsum("dn,dnl,dn->dl", Cc, P, dB).real
        L2 = 2 * L
        Kp = _pad(K, ((0, 0), (0, L)))
        up = (lambda x, *d: x.permute(*d))(u, 0, 2, 1)
        up = _pad(up, ((0, 0), (0, 0), (0, L)))
        Kf = (lambda x, axes=(-2,-1): torch.fft.rfft2(x.float(), dim=axes))(Kp[:, None, :], axes=(-2, -1))
        Uf = (lambda x, axes=(-2,-1): torch.fft.rfft2(x.float(), dim=axes))(up[:, :, None, :], axes=(-2, -1))
        Yf = Uf * Kf[None, :, :, :]
        y = (lambda x, s, axes=(-2,-1): torch.fft.irfft2(x, s=s, dim=axes).to(torch.bfloat16))(Yf, (1, L2), axes=(-2, -1))[:, :, 0, :L]
        y = (lambda x, *d: x.permute(*d))(y, 0, 2, 1) + u * Dskip[None, None, :]
        return y

    a = _A_ref(A_x, A_c_kv, A_w_q, A_w_uk, A_w_uv, A_w_o)
    b = _B_ref(B_u, B_A_re, B_A_im, B_B_re, B_B_im, B_C_re, B_C_im, B_log_dt, B_Dskip)
    return torch.concatenate([a, b], axis=-1)
```

```asm
; @launch kernel=qkv_kernel grid=(256,1,1) block=(512,1,1) lds=163840
; @launch kernel=attn_kernel grid=(256,1,1) block=(512,1,1) lds=163840
; @launch kernel=tail_kernel grid=(512,1,1) block=(512,1,1) lds=73728
.amdgcn_target "amdgcn-amd-amdhsa--gfx950"
.text
.globl qkv_kernel
.p2align 8
.type qkv_kernel,@function
qkv_kernel:
    s_cmp_ge_u32 s2, 256
    s_cbranch_scc1 qkv_kernel_done
    s_load_dwordx4 s[36:39], s[0:1], 0
    s_load_dwordx4 s[40:43], s[0:1], 16
    s_load_dwordx4 s[60:63], s[0:1], 32
    s_load_dwordx2 s[46:47], s[0:1], 136
    v_and_b32 v1, 63, v0
    v_lshrrev_b32 v9, 6, v0
    s_nop 0
    v_readfirstlane_b32 s24, v9
    s_cmp_ge_u32 s2, 32
    s_cbranch_scc1 qkv_kernel_nopf
    s_getpc_b64 s[70:71]
qkv_kernel_pc:
    s_sub_u32 s70, s70, qkv_kernel_pc-qkv_kernel
    s_subb_u32 s71, s71, 0
    s_lshr_b32 s27, s2, 3
    s_lshl_b32 s27, s27, 3
    s_add_u32 s27, s27, s24
    s_lshl_b32 s27, s27, 11
    v_lshlrev_b32 v110, 4, v1
    v_add_u32 v110, s27, v110
    v_add_u32 v111, 0x400, v110
    s_mov_b32 s27, code_end-qkv_kernel-16
    v_min_u32 v110, s27, v110
    v_min_u32 v111, s27, v111
    global_load_dwordx4 v[112:115], v110, s[70:71]
    global_load_dwordx4 v[116:119], v111, s[70:71]
qkv_kernel_nopf:
    s_and_b32 s25, s2, 7
    s_lshl_b32 s25, s25, 2
    s_lshr_b32 s26, s2, 3
    s_and_b32 s26, s26, 3
    s_add_u32 s25, s25, s26
    s_lshr_b32 s26, s2, 5
    s_cmp_lt_u32 s25, 11
    s_cbranch_scc0 qkv_kernel_kv
    s_mul_i32 s30, s25, 12
    s_sub_i32 s27, s25, 7
    s_max_i32 s27, s27, 0
    s_sub_u32 s30, s30, s27
    s_cmp_lt_u32 s25, 7
    s_cselect_b32 s27, 12, 11
    s_add_u32 s31, s30, s27
    s_waitcnt lgkmcnt(0)
    s_mov_b32 s8, s36
    s_and_b32 s9, s37, 0xffff
    s_mov_b32 s10, 2097152
    s_mov_b32 s11, 0x00020000
    s_mov_b32 s12, s40
    s_and_b32 s13, s41, 0xffff
    s_mov_b32 s14, 4194304
    s_mov_b32 s15, 0x00020000
    s_mov_b32 s20, s40
    s_and_b32 s21, s41, 0xffff
    s_mov_b32 s22, 4194304
    s_mov_b32 s23, 0x00020000
    s_mov_b32 s29, 0
    s_mov_b32 s77, 0x3E0293EE
    s_sub_u32 s57, s25, 7
    s_branch qkv_kernel_go
qkv_kernel_kv:
    s_sub_u32 s25, s25, 11
    s_mul_i32 s30, s25, 12
    s_min_u32 s27, s25, 4
    s_add_u32 s30, s30, s27
    s_cmp_lt_u32 s25, 4
    s_cselect_b32 s27, 13, 12
    s_add_u32 s31, s30, s27
    s_waitcnt lgkmcnt(0)
    s_mov_b32 s8, s38
    s_and_b32 s9, s39, 0xffff
    s_mov_b32 s10, 2097152
    s_mov_b32 s11, 0x00020000
    s_mov_b32 s12, s42
    s_and_b32 s13, s43, 0xffff
    s_mov_b32 s14, 4194304
    s_mov_b32 s15, 0x00020000
    s_mov_b32 s20, s60
    s_and_b32 s21, s61, 0xffff
    s_mov_b32 s22, 4194304
    s_mov_b32 s23, 0x00020000
    s_mov_b32 s29, 16777216
    s_mov_b32 s77, 1.0
    s_mov_b32 s57, -1
qkv_kernel_go:
    s_mov_b32 s16, s46
    s_and_b32 s17, s47, 0xffff
    s_mov_b32 s18, 268435456
    s_mov_b32 s19, 0x00020000
    s_sub_u32 s27, s31, s30
    s_lshr_b32 s64, s27, 1
    s_add_u32 s65, s27, 1
    s_lshr_b32 s65, s65, 1
    s_sub_u32 s67, s31, 2
    s_sub_u32 s69, s31, 1
    s_bitcmp1_b32 s30, 0
    s_cselect_b32 s67, s67, s30
    s_cselect_b32 s68, -2, 2
    s_cselect_b32 s69, s30, s69
    s_mov_b32 s66, 0
    s_mov_b32 s30, s67
    s_lshl_b32 s32, s26, 8
    s_lshl_b32 s27, s24, 5
    s_add_u32 s32, s32, s27
    v_and_b32 v10, 31, v1
    v_lshrrev_b32 v11, 5, v1
    v_lshrrev_b32 v12, 3, v1
    s_lshl_b32 s27, s24, 5
    v_add_u32 v12, s27, v12
    v_lshlrev_b32 v12, 13, v12
    v_and_b32 v13, 7, v1
    v_bfe_u32 v14, v1, 4, 1
    v_lshlrev_b32 v14, 2, v14
    v_xor_b32 v13, v13, v14
    v_lshl_add_u32 v4, v13, 4, v12
    v_lshrrev_b32 v12, 3, v1
    v_add_u32 v12, s32, v12
    v_lshlrev_b32 v12, 10, v12
    v_and_b32 v13, 7, v1
    v_lshrrev_b32 v14, 4, v1
    v_xor_b32 v13, v13, v14
    v_lshl_add_u32 v7, v13, 4, v12
    v_xor_b32 v15, 64, v7
    v_bfe_u32 v12, v10, 1, 3
    v_xor_b32 v12, v12, v11
    v_lshlrev_b32 v12, 4, v12
    v_lshl_add_u32 v12, v10, 7, v12
    s_mul_i32 s27, s24, 12288
    s_add_u32 s27, s27, 65536
    v_add_u32 v96, s27, v12
    v_xor_b32 v97, 32, v96
    v_xor_b32 v98, 64, v96
    v_xor_b32 v99, 96, v96
    s_mov_b32 s52, s27
    s_lshl_b32 s34, s24, 12
    s_mov_b32 s53, 0
    s_lshr_b32 s28, s53, 1
    s_mul_i32 s27, s28, s68
    s_add_u32 s27, s27, s67
    s_cmp_ge_u32 s28, s64
    s_cselect_b32 s27, s69, s27
    s_cmp_ge_u32 s27, 128
    s_cselect_b32 s12, s20, s12
    s_cselect_b32 s13, s21, s13
    s_and_b32 s27, s27, 127
    s_lshl_b32 s54, s27, 6
    s_and_b32 s27, s53, 1
    s_lshl_b32 s27, s27, 21
    s_add_u32 s54, s54, s27
    s_and_b32 s27, s53, 3
    s_lshl_b32 s27, s27, 15
    s_add_u32 s55, s27, s34
    s_add_u32 s53, s53, 1
    s_add_u32 m0, s55, 0
    s_add_u32 s35, s54, 0
    buffer_load_dwordx4 v4, s[12:15], s35 offen lds
    s_add_u32 m0, s55, 1024
    s_add_u32 s35, s54, 65536
    buffer_load_dwordx4 v4, s[12:15], s35 offen lds
    s_add_u32 m0, s55, 2048
    s_add_u32 s35, s54, 131072
    buffer_load_dwordx4 v4, s[12:15], s35 offen lds
    s_add_u32 m0, s55, 3072
    s_add_u32 s35, s54, 196608
    buffer_load_dwordx4 v4, s[12:15], s35 offen lds
    s_add_u32 m0, s52, 0
    s_mov_b32 s35, 0
    buffer_load_dwordx4 v7, s[8:11], s35 offen lds
    s_add_u32 m0, s52, 1024
    s_mov_b32 s35, 8192
    buffer_load_dwordx4 v15, s[8:11], s35 offen lds
    s_add_u32 m0, s52, 2048
    s_mov_b32 s35, 16384
    buffer_load_dwordx4 v7, s[8:11], s35 offen lds
    s_add_u32 m0, s52, 3072
    s_mov_b32 s35, 24576
    buffer_load_dwordx4 v15, s[8:11], s35 offen lds
    s_lshr_b32 s28, s53, 1
    s_mul_i32 s27, s28, s68
    s_add_u32 s27, s27, s67
    s_cmp_ge_u32 s28, s64
    s_cselect_b32 s27, s69, s27
    s_cmp_ge_u32 s27, 128
    s_cselect_b32 s12, s20, s12
    s_cselect_b32 s13, s21, s13
    s_and_b32 s27, s27, 127
    s_lshl_b32 s54, s27, 6
    s_and_b32 s27, s53, 1
    s_lshl_b32 s27, s27, 21
    s_add_u32 s54, s54, s27
    s_and_b32 s27, s53, 3
    s_lshl_b32 s27, s27, 15
    s_add_u32 s55, s27, s34
    s_add_u32 s53, s53, 1
    s_add_u32 m0, s55, 0
    s_add_u32 s35, s54, 0
    buffer_load_dwordx4 v4, s[12:15], s35 offen lds
    s_add_u32 m0, s55, 1024
    s_add_u32 s35, s54, 65536
    buffer_load_dwordx4 v4, s[12:15], s35 offen lds
    s_add_u32 m0, s55, 2048
    s_add_u32 s35, s54, 131072
    buffer_load_dwordx4 v4, s[12:15], s35 offen lds
    s_add_u32 m0, s55, 3072
    s_add_u32 s35, s54, 196608
    buffer_load_dwordx4 v4, s[12:15], s35 offen lds
    s_add_u32 m0, s52, 4096
    s_mov_b32 s35, 128
    buffer_load_dwordx4 v7, s[8:11], s35 offen lds
    s_add_u32 m0, s52, 5120
    s_mov_b32 s35, 8320
    buffer_load_dwordx4 v15, s[8:11], s35 offen lds
    s_add_u32 m0, s52, 6144
    s_mov_b32 s35, 16512
    buffer_load_dwordx4 v7, s[8:11], s35 offen lds
    s_add_u32 m0, s52, 7168
    s_mov_b32 s35, 24704
    buffer_load_dwordx4 v15, s[8:11], s35 offen lds
    s_add_u32 m0, s52, 8192
    s_mov_b32 s35, 256
    buffer_load_dwordx4 v7, s[8:11], s35 offen lds
    s_add_u32 m0, s52, 9216
    s_mov_b32 s35, 8448
    buffer_load_dwordx4 v15, s[8:11], s35 offen lds
    s_add_u32 m0, s52, 10240
    s_mov_b32 s35, 16640
    buffer_load_dwordx4 v7, s[8:11], s35 offen lds
    s_add_u32 m0, s52, 11264
    s_mov_b32 s35, 24832
    buffer_load_dwordx4 v15, s[8:11], s35 offen lds
    v_lshlrev_b32 v120, 13, v0
    s_mov_b32 s74, s14
    s_mov_b32 s75, s15
    s_add_u32 s28, s26, 1
    s_mul_i32 s27, s28, s68
    s_add_u32 s27, s27, s67
    s_cmp_ge_u32 s28, s64
    s_cselect_b32 s27, s69, s27
    s_cmp_ge_u32 s27, 128
    s_cselect_b32 s72, s20, s12
    s_cselect_b32 s73, s21, s13
    s_and_b32 s27, s27, 127
    s_lshl_b32 s27, s27, 6
    buffer_load_dword v121, v120, s[72:75], s27 offen
    s_lshl_b32 s27, s32, 8
    v_lshlrev_b32 v5, 4, v1
    v_add_u32 v5, s27, v5
    v_add_u32 v6, 0x1000, v5
    v_lshrrev_b32 v12, 5, v1
    v_lshlrev_b32 v12, 3, v12
    v_bfe_u32 v13, v1, 2, 2
    v_add_u32 v12, v12, v13
    v_lshlrev_b32 v12, 7, v12
    v_bfe_u32 v13, v1, 3, 1
    v_lshl_add_u32 v12, v13, 6, v12
    v_bfe_u32 v13, v1, 4, 1
    v_lshl_add_u32 v12, v13, 5, v12
    v_and_b32 v13, 3, v1
    v_lshl_add_u32 v2, v13, 3, v12
    v_xor_b32 v3, 64, v2
    v_mov_b32 v8, 0
    v_add_u32 v103, 0x400, v5
    s_mov_b32 s33, 0x10000000
    s_and_b32 s49, s30, 127
    s_lshl_b32 s49, s49, 5
    s_waitcnt vmcnt(17)
    s_barrier
    s_cmp_ge_u32 s30, 128
    s_cbranch_scc1 qkv_kernel_firstV
    s_add_u32 s27, s49, 0
    s_lshr_b32 s50, s27, 7
    s_lshl_b32 s50, s50, 19
    s_and_b32 s27, s27, 127
    s_lshl_b32 s27, s27, 6
    s_add_u32 s50, s50, s27
    s_add_u32 s50, s50, s29
    s_add_u32 s27, s49, 32
    s_lshr_b32 s51, s27, 7
    s_lshl_b32 s51, s51, 19
    s_and_b32 s27, s27, 127
    s_lshl_b32 s27, s27, 6
    s_add_u32 s51, s51, s27
    s_add_u32 s51, s51, s29
    s_waitcnt vmcnt(13)
    ds_read_b128 a[0:3], v96 offset:0
    ds_read_b128 a[4:7], v97 offset:0
    ds_read_b128 a[8:11], v98 offset:0
    ds_read_b128 a[12:15], v99 offset:0
    ds_read_b64_tr_b16 v[48:49], v2 offset:0
    ds_read_b64_tr_b16 v[50:51], v2 offset:512
    ds_read_b64_tr_b16 v[52:53], v3 offset:0
    ds_read_b64_tr_b16 v[54:55], v3 offset:512
    ds_read_b64_tr_b16 v[56:57], v2 offset:2048
    ds_read_b64_tr_b16 v[58:59], v2 offset:2560
    ds_read_b64_tr_b16 v[60:61], v3 offset:2048
    ds_read_b64_tr_b16 v[62:63], v3 offset:2560
    s_waitcnt lgkmcnt(8)
    s_add_u32 m0, s52, 0
    s_mov_b32 s35, 384
    buffer_load_dwordx4 v7, s[8:11], s35 offen lds
    s_add_u32 m0, s52, 1024
    s_mov_b32 s35, 8576
    buffer_load_dwordx4 v15, s[8:11], s35 offen lds
    s_add_u32 m0, s52, 2048
    s_mov_b32 s35, 16768
    buffer_load_dwordx4 v7, s[8:11], s35 offen lds
    s_add_u32 m0, s52, 3072
    s_mov_b32 s35, 24960
    buffer_load_dwordx4 v15, s[8:11], s35 offen lds
    ds_read_b64_tr_b16 v[64:65], v2 offset:4096
    ds_read_b64_tr_b16 v[66:67], v2 offset:4608
    s_waitcnt lgkmcnt(8)
    v_mfma_f32_32x32x16_bf16 v[16:31], v[48:51], a[0:3], 0
    ds_read_b64_tr_b16 v[68:69], v3 offset:4096
    ds_read_b64_tr_b16 v[70:71], v3 offset:4608
    s_waitcnt lgkmcnt(8)
    v_mfma_f32_32x32x16_bf16 v[32:47], v[52:55], a[0:3], 0
    ds_read_b64_tr_b16 v[72:73], v2 offset:6144
    ds_read_b64_tr_b16 v[74:75], v2 offset:6656
    s_waitcnt lgkmcnt(8)
    v_mfma_f32_32x32x16_bf16 v[16:31], v[56:59], a[4:7], v[16:31]
    ds_read_b64_tr_b16 v[76:77], v3 offset:6144
    ds_read_b64_tr_b16 v[78:79], v3 offset:6656
    s_waitcnt lgkmcnt(8)
    v_mfma_f32_32x32x16_bf16 v[32:47], v[60:63], a[4:7], v[32:47]
    s_waitcnt lgkmcnt(6)
    v_mfma_f32_32x32x16_bf16 v[16:31], v[64:67], a[8:11], v[16:31]
    s_waitcnt lgkmcnt(4)
    v_mfma_f32_32x32x16_bf16 v[32:47], v[68:71], a[8:11], v[32:47]
    s_waitcnt lgkmcnt(2)
    v_mfma_f32_32x32x16_bf16 v[16:31], v[72:75], a[12:15], v[16:31]
    s_waitcnt lgkmcnt(0)
    v_mfma_f32_32x32x16_bf16 v[32:47], v[76:79], a[12:15], v[32:47]
    s_waitcnt vmcnt(9)
    ds_read_b128 a[16:19], v96 offset:4096
    ds_read_b128 a[20:23], v97 offset:4096
    ds_read_b128 a[24:27], v98 offset:4096
    ds_read_b128 a[28:31], v99 offset:4096
    ds_read_b64_tr_b16 v[48:49], v2 offset:8192
    ds_read_b64_tr_b16 v[50:51], v2 offset:8704
    ds_read_b64_tr_b16 v[52:53], v3 offset:8192
    ds_read_b64_tr_b16 v[54:55], v3 offset:8704
    ds_read_b64_tr_b16 v[56:57], v2 offset:10240
    ds_read_b64_tr_b16 v[58:59], v2 offset:10752
    ds_read_b64_tr_b16 v[60:61], v3 offset:10240
    ds_read_b64_tr_b16 v[62:63], v3 offset:10752
    s_waitcnt lgkmcnt(8)
    s_add_u32 m0, s52, 4096
    s_mov_b32 s35, 512
    buffer_load_dwordx4 v7, s[8:11], s35 offen lds
    s_add_u32 m0, s52, 5120
    s_mov_b32 s35, 8704
    buffer_load_dwordx4 v15, s[8:11], s35 offen lds
    s_add_u32 m0, s52, 6144
    s_mov_b32 s35, 16896
    buffer_load_dwordx4 v7, s[8:11], s35 offen lds
    s_add_u32 m0, s52, 7168
    s_mov_b32 s35, 25088
    buffer_load_dwordx4 v15, s[8:11], s35 offen lds
    ds_read_b64_tr_b16 v[64:65], v2 offset:12288
    ds_read_b64_tr_b16 v[66:67], v2 offset:12800
    s_waitcnt lgkmcnt(8)
    v_mfma_f32_32x32x16_bf16 v[16:31], v[48:51], a[16:19], v[16:31]
    ds_read_b64_tr_b16 v[68:69], v3 offset:12288
    ds_read_b64_tr_b16 v[70:71], v3 offset:12800
    s_waitcnt lgkmcnt(8)
    v_mfma_f32_32x32x16_bf16 v[32:47], v[52:55], a[16:19], v[32:47]
    ds_read_b64_tr_b16 v[72:73], v2 offset:14336
    ds_read_b64_tr_b16 v[74:75], v2 offset:14848
    s_waitcnt lgkmcnt(8)
    v_mfma_f32_32x32x16_bf16 v[16:31], v[56:59], a[20:23], v[16:31]
    ds_read_b64_tr_b16 v[76:77], v3 offset:14336
    ds_read_b64_tr_b16 v[78:79], v3 offset:14848
    s_waitcnt lgkmcnt(8)
    v_mfma_f32_32x32x16_bf16 v[32:47], v[60:63], a[20:23], v[32:47]
    s_waitcnt lgkmcnt(6)
    v_mfma_f32_32x32x16_bf16 v[16:31], v[64:67], a[24:27], v[16:31]
    s_waitcnt lgkmcnt(4)
    v_mfma_f32_32x32x16_bf16 v[32:47], v[68:71], a[24:27], v[32:47]
    s_waitcnt lgkmcnt(2)
    v_mfma_f32_32x32x16_bf16 v[16:31], v[72:75], a[28:31], v[16:31]
    s_waitcnt lgkmcnt(0)
    v_mfma_f32_32x32x16_bf16 v[32:47], v[76:79], a[28:31], v[32:47]
    s_waitcnt vmcnt(9)
    ds_read_b128 a[32:35], v96 offset:8192
    ds_read_b128 a[36:39], v97 offset:8192
    ds_read_b128 a[40:43], v98 offset:8192
    ds_read_b128 a[44:47], v99 offset:8192
    ds_read_b64_tr_b16 v[48:49], v2 offset:16384
    ds_read_b64_tr_b16 v[50:51], v2 offset:16896
    ds_read_b64_tr_b16 v[52:53], v3 offset:16384
    ds_read_b64_tr_b16 v[54:55], v3 offset:16896
    ds_read_b64_tr_b16 v[56:57], v2 offset:18432
    ds_read_b64_tr_b16 v[58:59], v2 offset:18944
    ds_read_b64_tr_b16 v[60:61], v3 offset:18432
    ds_read_b64_tr_b16 v[62:63], v3 offset:18944
    s_waitcnt lgkmcnt(8)
    s_add_u32 m0, s52, 8192
    s_mov_b32 s35, 640
    buffer_load_dwordx4 v7, s[8:11], s35 offen lds
    s_add_u32 m0, s52, 9216
    s_mov_b32 s35, 8832
    buffer_load_dwordx4 v15, s[8:11], s35 offen lds
    s_add_u32 m0, s52, 10240
    s_mov_b32 s35, 17024
    buffer_load_dwordx4 v7, s[8:11], s35 offen lds
    s_add_u32 m0, s52, 11264
    s_mov_b32 s35, 25216
    buffer_load_dwordx4 v15, s[8:11], s35 offen lds
    ds_read_b64_tr_b16 v[64:65], v2 offset:20480
    ds_read_b64_tr_b16 v[66:67], v2 offset:20992
    s_waitcnt lgkmcnt(8)
    v_mfma_f32_32x32x16_bf16 v[16:31], v[48:51], a[32:35], v[16:31]
    ds_read_b64_tr_b16 v[68:69], v3 offset:20480
    ds_read_b64_tr_b16 v[70:71], v3 offset:20992
    s_waitcnt lgkmcnt(8)
    v_mfma_f32_32x32x16_bf16 v[32:47], v[52:55], a[32:35], v[32:47]
    ds_read_b64_tr_b16 v[72:73], v2 offset:22528
    ds_read_b64_tr_b16 v[74:75], v2 offset:23040
    s_waitcnt lgkmcnt(8)
    v_mfma_f32_32x32x16_bf16 v[16:31], v[56:59], a[36:39], v[16:31]
    ds_read_b64_tr_b16 v[76:77], v3 offset:22528
    ds_read_b64_tr_b16 v[78:79], v3 offset:23040
    s_waitcnt lgkmcnt(8)
    v_mfma_f32_32x32x16_bf16 v[32:47], v[60:63], a[36:39], v[32:47]
    s_waitcnt lgkmcnt(6)
    v_mfma_f32_32x32x16_bf16 v[16:31], v[64:67], a[40:43], v[16:31]
    s_waitcnt lgkmcnt(4)
    v_mfma_f32_32x32x16_bf16 v[32:47], v[68:71], a[40:43], v[32:47]
    s_waitcnt lgkmcnt(2)
    v_mfma_f32_32x32x16_bf16 v[16:31], v[72:75], a[44:47], v[16:31]
    s_waitcnt lgkmcnt(0)
    v_mfma_f32_32x32x16_bf16 v[32:47], v[76:79], a[44:47], v[32:47]
    s_waitcnt vmcnt(8)
    ds_read_b128 a[48:51], v96 offset:0
    ds_read_b128 a[52:55], v97 offset:0
    ds_read_b128 a[56:59], v98 offset:0
    ds_read_b128 a[60:63], v99 offset:0
    ds_read_b64_tr_b16 v[48:49], v2 offset:24576
    ds_read_b64_tr_b16 v[50:51], v2 offset:25088
    ds_read_b64_tr_b16 v[52:53], v3 offset:24576
    ds_read_b64_tr_b16 v[54:55], v3 offset:25088
    ds_read_b64_tr_b16 v[56:57], v2 offset:26624
    ds_read_b64_tr_b16 v[58:59], v2 offset:27136
    ds_read_b64_tr_b16 v[60:61], v3 offset:26624
    ds_read_b64_tr_b16 v[62:63], v3 offset:27136
    s_waitcnt lgkmcnt(8)
    s_add_u32 m0, s52, 0
    s_mov_b32 s35, 768
    buffer_load_dwordx4 v7, s[8:11], s35 offen lds
    s_add_u32 m0, s52, 1024
    s_mov_b32 s35, 8960
    buffer_load_dwordx4 v15, s[8:11], s35 offen lds
    s_add_u32 m0, s52, 2048
    s_mov_b32 s35, 17152
    buffer_load_dwordx4 v7, s[8:11], s35 offen lds
    s_add_u32 m0, s52, 3072
    s_mov_b32 s35, 25344
    buffer_load_dwordx4 v15, s[8:11], s35 offen lds
    ds_read_b64_tr_b16 v[64:65], v2 offset:28672
    ds_read_b64_tr_b16 v[66:67], v2 offset:29184
    s_waitcnt lgkmcnt(8)
    v_mfma_f32_32x32x16_bf16 v[16:31], v[48:51], a[48:51], v[16:31]
    ds_read_b64_tr_b16 v[68:69], v3 offset:28672
    ds_read_b64_tr_b16 v[70:71], v3 offset:29184
    s_waitcnt lgkmcnt(8)
    v_mfma_f32_32x32x16_bf16 v[32:47], v[52:55], a[48:51], v[32:47]
    ds_read_b64_tr_b16 v[72:73], v2 offset:30720
    ds_read_b64_tr_b16 v[74:75], v2 offset:31232
    s_waitcnt lgkmcnt(8)
    v_mfma_f32_32x32x16_bf16 v[16:31], v[56:59], a[52:55], v[16:31]
    ds_read_b64_tr_b16 v[76:77], v3 offset:30720
    ds_read_b64_tr_b16 v[78:79], v3 offset:31232
    s_waitcnt lgkmcnt(8)
    v_mfma_f32_32x32x16_bf16 v[32:47], v[60:63], a[52:55], v[32:47]
    s_waitcnt lgkmcnt(6)
    v_mfma_f32_32x32x16_bf16 v[16:31], v[64:67], a[56:59], v[16:31]
    s_waitcnt lgkmcnt(4)
    v_mfma_f32_32x32x16_bf16 v[32:47], v[68:71], a[56:59], v[32:47]
    s_waitcnt lgkmcnt(2)
    v_mfma_f32_32x32x16_bf16 v[16:31], v[72:75], a[60:63], v[16:31]
    s_waitcnt lgkmcnt(0)
    v_mfma_f32_32x32x16_bf16 v[32:47], v[76:79], a[60:63], v[32:47]
    s_waitcnt vmcnt(8)
    s_barrier
    ds_read_b128 a[64:67], v96 offset:4096
    ds_read_b128 a[68:71], v97 offset:4096
    ds_read_b128 a[72:75], v98 offset:4096
    ds_read_b128 a[76:79], v99 offset:4096
    ds_read_b64_tr_b16 v[48:49], v2 offset:32768
    ds_read_b64_tr_b16 v[50:51], v2 offset:33280
    ds_read_b64_tr_b16 v[52:53], v3 offset:32768
    ds_read_b64_tr_b16 v[54:55], v3 offset:33280
    ds_read_b64_tr_b16 v[56:57], v2 offset:34816
    ds_read_b64_tr_b16 v[58:59], v2 offset:35328
    ds_read_b64_tr_b16 v[60:61], v3 offset:34816
    ds_read_b64_tr_b16 v[62:63], v3 offset:35328
    s_waitcnt lgkmcnt(8)
    s_add_u32 m0, s52, 4096
    s_mov_b32 s35, 896
    buffer_load_dwordx4 v7, s[8:11], s35 offen lds
    s_add_u32 m0, s52, 5120
    s_mov_b32 s35, 9088
    buffer_load_dwordx4 v15, s[8:11], s35 offen lds
    s_add_u32 m0, s52, 6144
    s_mov_b32 s35, 17280
    buffer_load_dwordx4 v7, s[8:11], s35 offen lds
    s_add_u32 m0, s52, 7168
    s_mov_b32 s35, 25472
    buffer_load_dwordx4 v15, s[8:11], s35 offen lds
    ds_read_b64_tr_b16 v[64:65], v2 offset:36864
    ds_read_b64_tr_b16 v[66:67], v2 offset:37376
    s_waitcnt lgkmcnt(8)
    v_mfma_f32_32x32x16_bf16 v[16:31], v[48:51], a[64:67], v[16:31]
    ds_read_b64_tr_b16 v[68:69], v3 offset:36864
    ds_read_b64_tr_b16 v[70:71], v3 offset:37376
    s_waitcnt lgkmcnt(8)
    v_mfma_f32_32x32x16_bf16 v[32:47], v[52:55], a[64:67], v[32:47]
    ds_read_b64_tr_b16 v[72:73], v2 offset:38912
    ds_read_b64_tr_b16 v[74:75], v2 offset:39424
    s_waitcnt lgkmcnt(8)
    v_mfma_f32_32x32x16_bf16 v[16:31], v[56:59], a[68:71], v[16:31]
    ds_read_b64_tr_b16 v[76:77], v3 offset:38912
    ds_read_b64_tr_b16 v[78:79], v3 offset:39424
    s_waitcnt lgkmcnt(8)
    v_mfma_f32_32x32x16_bf16 v[32:47], v[60:63], a[68:71], v[32:47]
    s_waitcnt lgkmcnt(6)
    v_mfma_f32_32x32x16_bf16 v[16:31], v[64:67], a[72:75], v[16:31]
    s_waitcnt lgkmcnt(4)
    v_mfma_f32_32x32x16_bf16 v[32:47], v[68:71], a[72:75], v[32:47]
    s_waitcnt lgkmcnt(2)
    v_mfma_f32_32x32x16_bf16 v[16:31], v[72:75], a[76:79], v[16:31]
    s_waitcnt lgkmcnt(0)
    v_mfma_f32_32x32x16_bf16 v[32:47], v[76:79], a[76:79], v[32:47]
    s_waitcnt vmcnt(8)
    ds_read_b128 a[80:83], v96 offset:8192
    ds_read_b128 a[84:87], v97 offset:8192
    ds_read_b128 a[88:91], v98 offset:8192
    ds_read_b128 a[92:95], v99 offset:8192
    ds_read_b64_tr_b16 v[48:49], v2 offset:40960
    ds_read_b64_tr_b16 v[50:51], v2 offset:41472
    ds_read_b64_tr_b16 v[52:53], v3 offset:40960
    ds_read_b64_tr_b16 v[54:55], v3 offset:41472
    ds_read_b64_tr_b16 v[56:57], v2 offset:43008
    ds_read_b64_tr_b16 v[58:59], v2 offset:43520
    ds_read_b64_tr_b16 v[60:61], v3 offset:43008
    ds_read_b64_tr_b16 v[62:63], v3 offset:43520
    s_waitcnt lgkmcnt(8)
    ds_read_b64_tr_b16 v[64:65], v2 offset:45056
    ds_read_b64_tr_b16 v[66:67], v2 offset:45568
    s_waitcnt lgkmcnt(8)
    v_mfma_f32_32x32x16_bf16 v[16:31], v[48:51], a[80:83], v[16:31]
    ds_read_b64_tr_b16 v[68:69], v3 offset:45056
    ds_read_b64_tr_b16 v[70:71], v3 offset:45568
    s_waitcnt lgkmcnt(8)
    v_mfma_f32_32x32x16_bf16 v[32:47], v[52:55], a[80:83], v[32:47]
    ds_read_b64_tr_b16 v[72:73], v2 offset:47104
    ds_read_b64_tr_b16 v[74:75], v2 offset:47616
    s_waitcnt lgkmcnt(8)
    v_mfma_f32_32x32x16_bf16 v[16:31], v[56:59], a[84:87], v[16:31]
    ds_read_b64_tr_b16 v[76:77], v3 offset:47104
    ds_read_b64_tr_b16 v[78:79], v3 offset:47616
    s_waitcnt lgkmcnt(8)
    v_mfma_f32_32x32x16_bf16 v[32:47], v[60:63], a[84:87], v[32:47]
    s_waitcnt lgkmcnt(6)
    v_mfma_f32_32x32x16_bf16 v[16:31], v[64:67], a[88:91], v[16:31]
    s_waitcnt lgkmcnt(4)
    v_mfma_f32_32x32x16_bf16 v[32:47], v[68:71], a[88:91], v[32:47]
    s_waitcnt lgkmcnt(2)
    v_mfma_f32_32x32x16_bf16 v[16:31], v[72:75], a[92:95], v[16:31]
    s_waitcnt lgkmcnt(0)
    v_mfma_f32_32x32x16_bf16 v[32:47], v[76:79], a[92:95], v[32:47]
    s_waitcnt vmcnt(4)
    ds_read_b128 a[96:99], v96 offset:0
    ds_read_b128 a[100:103], v97 offset:0
    ds_read_b128 a[104:107], v98 offset:0
    ds_read_b128 a[108:111], v99 offset:0
    ds_read_b64_tr_b16 v[48:49], v2 offset:49152
    ds_read_b64_tr_b16 v[50:51], v2 offset:49664
    ds_read_b64_tr_b16 v[52:53], v3 offset:49152
    ds_read_b64_tr_b16 v[54:55], v3 offset:49664
    ds_read_b64_tr_b16 v[56:57], v2 offset:51200
    ds_read_b64_tr_b16 v[58:59], v2 offset:51712
    ds_read_b64_tr_b16 v[60:61], v3 offset:51200
    ds_read_b64_tr_b16 v[62:63], v3 offset:51712
    s_waitcnt lgkmcnt(8)
    ds_read_b64_tr_b16 v[64:65], v2 offset:53248
    ds_read_b64_tr_b16 v[66:67], v2 offset:53760
    s_waitcnt lgkmcnt(8)
    v_mfma_f32_32x32x16_bf16 v[16:31], v[48:51], a[96:99], v[16:31]
    ds_read_b64_tr_b16 v[68:69], v3 offset:53248
    ds_read_b64_tr_b16 v[70:71], v3 offset:53760
    s_waitcnt lgkmcnt(8)
    v_mfma_f32_32x32x16_bf16 v[32:47], v[52:55], a[96:99], v[32:47]
    ds_read_b64_tr_b16 v[72:73], v2 offset:55296
    ds_read_b64_tr_b16 v[74:75], v2 offset:55808
    s_waitcnt lgkmcnt(8)
    v_mfma_f32_32x32x16_bf16 v[16:31], v[56:59], a[100:103], v[16:31]
    ds_read_b64_tr_b16 v[76:77], v3 offset:55296
    ds_read_b64_tr_b16 v[78:79], v3 offset:55808
    s_waitcnt lgkmcnt(8)
    v_mfma_f32_32x32x16_bf16 v[32:47], v[60:63], a[100:103], v[32:47]
    s_waitcnt lgkmcnt(6)
    v_mfma_f32_32x32x16_bf16 v[16:31], v[64:67], a[104:107], v[16:31]
    s_waitcnt lgkmcnt(4)
    v_mfma_f32_32x32x16_bf16 v[32:47], v[68:71], a[104:107], v[32:47]
    s_waitcnt lgkmcnt(2)
    v_mfma_f32_32x32x16_bf16 v[16:31], v[72:75], a[108:111], v[16:31]
    s_waitcnt lgkmcnt(0)
    v_mfma_f32_32x32x16_bf16 v[32:47], v[76:79], a[108:111], v[32:47]
    s_waitcnt vmcnt(0)
    ds_read_b128 a[112:115], v96 offset:4096
    ds_read_b128 a[116:119], v97 offset:4096
    ds_read_b128 a[120:123], v98 offset:4096
    ds_read_b128 a[124:127], v99 offset:4096
    ds_read_b64_tr_b16 v[48:49], v2 offset:57344
    ds_read_b64_tr_b16 v[50:51], v2 offset:57856
    ds_read_b64_tr_b16 v[52:53], v3 offset:57344
    ds_read_b64_tr_b16 v[54:55], v3 offset:57856
    ds_read_b64_tr_b16 v[56:57], v2 offset:59392
    ds_read_b64_tr_b16 v[58:59], v2 offset:59904
    ds_read_b64_tr_b16 v[60:61], v3 offset:59392
    ds_read_b64_tr_b16 v[62:63], v3 offset:59904
    s_waitcnt lgkmcnt(8)
    ds_read_b64_tr_b16 v[64:65], v2 offset:61440
    ds_read_b64_tr_b16 v[66:67], v2 offset:61952
    s_waitcnt lgkmcnt(8)
    v_mfma_f32_32x32x16_bf16 v[16:31], v[48:51], a[112:115], v[16:31]
    ds_read_b64_tr_b16 v[68:69], v3 offset:61440
    ds_read_b64_tr_b16 v[70:71], v3 offset:61952
    s_waitcnt lgkmcnt(8)
    v_mfma_f32_32x32x16_bf16 v[32:47], v[52:55], a[112:115], v[32:47]
    ds_read_b64_tr_b16 v[72:73], v2 offset:63488
    ds_read_b64_tr_b16 v[74:75], v2 offset:64000
    s_waitcnt lgkmcnt(8)
    v_mfma_f32_32x32x16_bf16 v[16:31], v[56:59], a[116:119], v[16:31]
    ds_read_b64_tr_b16 v[76:77], v3 offset:63488
    ds_read_b64_tr_b16 v[78:79], v3 offset:64000
    s_waitcnt lgkmcnt(8)
    v_mfma_f32_32x32x16_bf16 v[32:47], v[60:63], a[116:119], v[32:47]
    s_waitcnt lgkmcnt(6)
    v_mfma_f32_32x32x16_bf16 v[16:31], v[64:67], a[120:123], v[16:31]
    s_waitcnt lgkmcnt(4)
    v_mfma_f32_32x32x16_bf16 v[32:47], v[68:71], a[120:123], v[32:47]
    s_waitcnt lgkmcnt(2)
    v_mfma_f32_32x32x16_bf16 v[16:31], v[72:75], a[124:127], v[16:31]
    s_waitcnt lgkmcnt(0)
    v_mfma_f32_32x32x16_bf16 v[32:47], v[76:79], a[124:127], v[32:47]
    s_barrier
    s_lshr_b32 s28, s53, 1
    s_mul_i32 s27, s28, s68
    s_add_u32 s27, s27, s67
    s_cmp_ge_u32 s28, s64
    s_cselect_b32 s27, s69, s27
    s_cmp_ge_u32 s27, 128
    s_cselect_b32 s12, s20, s12
    s_cselect_b32 s13, s21, s13
    s_and_b32 s27, s27, 127
    s_lshl_b32 s54, s27, 6
    s_and_b32 s27, s53, 1
    s_lshl_b32 s27, s27, 21
    s_add_u32 s54, s54, s27
    s_and_b32 s27, s53, 3
    s_lshl_b32 s27, s27, 15
    s_add_u32 s55, s27, s34
    s_add_u32 s53, s53, 1
    s_add_u32 m0, s55, 0
    s_add_u32 s35, s54, 0
    buffer_load_dwordx4 v4, s[12:15], s35 offen lds
    s_add_u32 m0, s55, 1024
    s_add_u32 s35, s54, 65536
    buffer_load_dwordx4 v4, s[12:15], s35 offen lds
    s_add_u32 m0, s55, 2048
    s_add_u32 s35, s54, 131072
    buffer_load_dwordx4 v4, s[12:15], s35 offen lds
    s_add_u32 m0, s55, 3072
    s_add_u32 s35, s54, 196608
    buffer_load_dwordx4 v4, s[12:15], s35 offen lds
    s_lshr_b32 s28, s53, 1
    s_mul_i32 s27, s28, s68
    s_add_u32 s27, s27, s67
    s_cmp_ge_u32 s28, s64
    s_cselect_b32 s27, s69, s27
    s_cmp_ge_u32 s27, 128
    s_cselect_b32 s12, s20, s12
    s_cselect_b32 s13, s21, s13
    s_and_b32 s27, s27, 127
    s_lshl_b32 s54, s27, 6
    s_and_b32 s27, s53, 1
    s_lshl_b32 s27, s27, 21
    s_add_u32 s54, s54, s27
    s_and_b32 s27, s53, 3
    s_lshl_b32 s27, s27, 15
    s_add_u32 s55, s27, s34
    s_add_u32 s53, s53, 1
    s_add_u32 m0, s55, 0
    s_add_u32 s35, s54, 0
    buffer_load_dwordx4 v4, s[12:15], s35 offen lds
    s_add_u32 m0, s55, 1024
    s_add_u32 s35, s54, 65536
    buffer_load_dwordx4 v4, s[12:15], s35 offen lds
    s_add_u32 m0, s55, 2048
    s_add_u32 s35, s54, 131072
    buffer_load_dwordx4 v4, s[12:15], s35 offen lds
    s_add_u32 m0, s55, 3072
    s_add_u32 s35, s54, 196608
    buffer_load_dwordx4 v4, s[12:15], s35 offen lds
    v_mul_f32 v16, s77, v16
    v_mul_f32 v17, s77, v17
    v_mul_f32 v18, s77, v18
    v_mul_f32 v19, s77, v19
    v_mul_f32 v20, s77, v20
    v_mul_f32 v21, s77, v21
    v_mul_f32 v22, s77, v22
    v_mul_f32 v23, s77, v23
    v_cvt_pk_bf16_f32 v80, v16, v17
    v_cvt_pk_bf16_f32 v81, v18, v19
    v_cvt_pk_bf16_f32 v82, v20, v21
    v_cvt_pk_bf16_f32 v83, v22, v23
    buffer_store_dwordx4 v[80:83], v5, s[16:19], s50 offen sc0 sc1
    v_mul_f32 v24, s77, v24
    v_mul_f32 v25, s77, v25
    v_mul_f32 v26, s77, v26
    v_mul_f32 v27, s77, v27
    v_mul_f32 v28, s77, v28
    v_mul_f32 v29, s77, v29
    v_mul_f32 v30, s77, v30
    v_mul_f32 v31, s77, v31
    v_cvt_pk_bf16_f32 v84, v24, v25
    v_cvt_pk_bf16_f32 v85, v26, v27
    v_cvt_pk_bf16_f32 v86, v28, v29
    v_cvt_pk_bf16_f32 v87, v30, v31
    buffer_store_dwordx4 v[84:87], v103, s[16:19], s50 offen sc0 sc1
    v_mov_b32 v8, v103
    s_mov_b32 s33, s51
    s_branch qkv_kernel_firstd
qkv_kernel_firstV:
    s_add_u32 s27, s49, 0
    s_lshr_b32 s50, s27, 7
    s_lshl_b32 s50, s50, 19
    s_and_b32 s27, s27, 127
    s_lshl_b32 s27, s27, 5
    s_add_u32 s50, s50, s27
    s_add_u32 s50, s50, 33554432
    s_add_u32 s27, s49, 32
    s_lshr_b32 s51, s27, 7
    s_lshl_b32 s51, s51, 19
    s_and_b32 s27, s27, 127
    s_lshl_b32 s27, s27, 5
    s_add_u32 s51, s51, s27
    s_add_u32 s51, s51, 33554432
    s_waitcnt vmcnt(13)
    ds_read_b128 a[0:3], v96 offset:0
    ds_read_b128 a[4:7], v97 offset:0
    ds_read_b128 a[8:11], v98 offset:0
    ds_read_b128 a[12:15], v99 offset:0
    ds_read_b64_tr_b16 v[48:49], v2 offset:0
    ds_read_b64_tr_b16 v[50:51], v2 offset:512
    ds_read_b64_tr_b16 v[52:53], v3 offset:0
    ds_read_b64_tr_b16 v[54:55], v3 offset:512
    ds_read_b64_tr_b16 v[56:57], v2 offset:2048
    ds_read_b64_tr_b16 v[58:59], v2 offset:2560
    ds_read_b64_tr_b16 v[60:61], v3 offset:2048
    ds_read_b64_tr_b16 v[62:63], v3 offset:2560
    s_waitcnt lgkmcnt(8)
    s_add_u32 m0, s52, 0
    s_mov_b32 s35, 384
    buffer_load_dwordx4 v7, s[8:11], s35 offen lds
    s_add_u32 m0, s52, 1024
    s_mov_b32 s35, 8576
    buffer_load_dwordx4 v15, s[8:11], s35 offen lds
    s_add_u32 m0, s52, 2048
    s_mov_b32 s35, 16768
    buffer_load_dwordx4 v7, s[8:11], s35 offen lds
    s_add_u32 m0, s52, 3072
    s_mov_b32 s35, 24960
    buffer_load_dwordx4 v15, s[8:11], s35 offen lds
    ds_read_b64_tr_b16 v[64:65], v2 offset:4096
    ds_read_b64_tr_b16 v[66:67], v2 offset:4608
    s_waitcnt lgkmcnt(8)
    v_mfma_f32_32x32x16_bf16 v[16:31], a[0:3], v[48:51], 0
    ds_read_b64_tr_b16 v[68:69], v3 offset:4096
    ds_read_b64_tr_b16 v[70:71], v3 offset:4608
    s_waitcnt lgkmcnt(8)
    v_mfma_f32_32x32x16_bf16 v[32:47], a[0:3], v[52:55], 0
    ds_read_b64_tr_b16 v[72:73], v2 offset:6144
    ds_read_b64_tr_b16 v[74:75], v2 offset:6656
    s_waitcnt lgkmcnt(8)
    v_mfma_f32_32x32x16_bf16 v[16:31], a[4:7], v[56:59], v[16:31]
    ds_read_b64_tr_b16 v[76:77], v3 offset:6144
    ds_read_b64_tr_b16 v[78:79], v3 offset:6656
    s_waitcnt lgkmcnt(8)
    v_mfma_f32_32x32x16_bf16 v[32:47], a[4:7], v[60:63], v[32:47]
    s_waitcnt lgkmcnt(6)
    v_mfma_f32_32x32x16_bf16 v[16:31], a[8:11], v[64:67], v[16:31]
    s_waitcnt lgkmcnt(4)
    v_mfma_f32_32x32x16_bf16 v[32:47], a[8:11], v[68:71], v[32:47]
    s_waitcnt lgkmcnt(2)
    v_mfma_f32_32x32x16_bf16 v[16:31], a[12:15], v[72:75], v[16:31]
    s_waitcnt lgkmcnt(0)
    v_mfma_f32_32x32x16_bf16 v[32:47], a[12:15], v[76:79], v[32:47]
    s_waitcnt vmcnt(9)
    ds_read_b128 a[16:19], v96 offset:4096
    ds_read_b128 a[20:23], v97 offset:4096
    ds_read_b128 a[24:27], v98 offset:4096
    ds_read_b128 a[28:31], v99 offset:4096
    ds_read_b64_tr_b16 v[48:49], v2 offset:8192
    ds_read_b64_tr_b16 v[50:51], v2 offset:8704
    ds_read_b64_tr_b16 v[52:53], v3 offset:8192
    ds_read_b64_tr_b16 v[54:55], v3 offset:8704
    ds_read_b64_tr_b16 v[56:57], v2 offset:10240
    ds_read_b64_tr_b16 v[58:59], v2 offset:10752
    ds_read_b64_tr_b16 v[60:61], v3 offset:10240
    ds_read_b64_tr_b16 v[62:63], v3 offset:10752
    s_waitcnt lgkmcnt(8)
    s_add_u32 m0, s52, 4096
    s_mov_b32 s35, 512
    buffer_load_dwordx4 v7, s[8:11], s35 offen lds
    s_add_u32 m0, s52, 5120
    s_mov_b32 s35, 8704
    buffer_load_dwordx4 v15, s[8:11], s35 offen lds
    s_add_u32 m0, s52, 6144
    s_mov_b32 s35, 16896
    buffer_load_dwordx4 v7, s[8:11], s35 offen lds
    s_add_u32 m0, s52, 7168
    s_mov_b32 s35, 25088
    buffer_load_dwordx4 v15, s[8:11], s35 offen lds
    ds_read_b64_tr_b16 v[64:65], v2 offset:12288
    ds_read_b64_tr_b16 v[66:67], v2 offset:12800
    s_waitcnt lgkmcnt(8)
    v_mfma_f32_32x32x16_bf16 v[16:31], a[16:19], v[48:51], v[16:31]
    ds_read_b64_tr_b16 v[68:69], v3 offset:12288
    ds_read_b64_tr_b16 v[70:71], v3 offset:12800
    s_waitcnt lgkmcnt(8)
    v_mfma_f32_32x32x16_bf16 v[32:47], a[16:19], v[52:55], v[32:47]
    ds_read_b64_tr_b16 v[72:73], v2 offset:14336
    ds_read_b64_tr_b16 v[74:75], v2 offset:14848
    s_waitcnt lgkmcnt(8)
    v_mfma_f32_32x32x16_bf16 v[16:31], a[20:23], v[56:59], v[16:31]
    ds_read_b64_tr_b16 v[76:77], v3 offset:14336
    ds_read_b64_tr_b16 v[78:79], v3 offset:14848
    s_waitcnt lgkmcnt(8)
    v_mfma_f32_32x32x16_bf16 v[32:47], a[20:23], v[60:63], v[32:47]
    s_waitcnt lgkmcnt(6)
    v_mfma_f32_32x32x16_bf16 v[16:31], a[24:27], v[64:67], v[16:31]
    s_waitcnt lgkmcnt(4)
    v_mfma_f32_32x32x16_bf16 v[32:47], a[24:27], v[68:71], v[32:47]
    s_waitcnt lgkmcnt(2)
    v_mfma_f32_32x32x16_bf16 v[16:31], a[28:31], v[72:75], v[16:31]
    s_waitcnt lgkmcnt(0)
    v_mfma_f32_32x32x16_bf16 v[32:47], a[28:31], v[76:79], v[32:47]
    s_waitcnt vmcnt(9)
    ds_read_b128 a[32:35], v96 offset:8192
    ds_read_b128 a[36:39], v97 offset:8192
    ds_read_b128 a[40:43], v98 offset:8192
    ds_read_b128 a[44:47], v99 offset:8192
    ds_read_b64_tr_b16 v[48:49], v2 offset:16384
    ds_read_b64_tr_b16 v[50:51], v2 offset:16896
    ds_read_b64_tr_b16 v[52:53], v3 offset:16384
    ds_read_b64_tr_b16 v[54:55], v3 offset:16896
    ds_read_b64_tr_b16 v[56:57], v2 offset:18432
    ds_read_b64_tr_b16 v[58:59], v2 offset:18944
    ds_read_b64_tr_b16 v[60:61], v3 offset:18432
    ds_read_b64_tr_b16 v[62:63], v3 offset:18944
    s_waitcnt lgkmcnt(8)
    s_add_u32 m0, s52, 8192
    s_mov_b32 s35, 640
    buffer_load_dwordx4 v7, s[8:11], s35 offen lds
    s_add_u32 m0, s52, 9216
    s_mov_b32 s35, 8832
    buffer_load_dwordx4 v15, s[8:11], s35 offen lds
    s_add_u32 m0, s52, 10240
    s_mov_b32 s35, 17024
    buffer_load_dwordx4 v7, s[8:11], s35 offen lds
    s_add_u32 m0, s52, 11264
    s_mov_b32 s35, 25216
    buffer_load_dwordx4 v15, s[8:11], s35 offen lds
    ds_read_b64_tr_b16 v[64:65], v2 offset:20480
    ds_read_b64_tr_b16 v[66:67], v2 offset:20992
    s_waitcnt lgkmcnt(8)
    v_mfma_f32_32x32x16_bf16 v[16:31], a[32:35], v[48:51], v[16:31]
    ds_read_b64_tr_b16 v[68:69], v3 offset:20480
    ds_read_b64_tr_b16 v[70:71], v3 offset:20992
    s_waitcnt lgkmcnt(8)
    v_mfma_f32_32x32x16_bf16 v[32:47], a[32:35], v[52:55], v[32:47]
    ds_read_b64_tr_b16 v[72:73], v2 offset:22528
    ds_read_b64_tr_b16 v[74:75], v2 offset:23040
    s_waitcnt lgkmcnt(8)
    v_mfma_f32_32x32x16_bf16 v[16:31], a[36:39], v[56:59], v[16:31]
    ds_read_b64_tr_b16 v[76:77], v3 offset:22528
    ds_read_b64_tr_b16 v[78:79], v3 offset:23040
    s_waitcnt lgkmcnt(8)
    v_mfma_f32_32x32x16_bf16 v[32:47], a[36:39], v[60:63], v[32:47]
    s_waitcnt lgkmcnt(6)
    v_mfma_f32_32x32x16_bf16 v[16:31], a[40:43], v[64:67], v[16:31]
    s_waitcnt lgkmcnt(4)
    v_mfma_f32_32x32x16_bf16 v[32:47], a[40:43], v[68:71], v[32:47]
    s_waitcnt lgkmcnt(2)
    v_mfma_f32_32x32x16_bf16 v[16:31], a[44:47], v[72:75], v[16:31]
    s_waitcnt lgkmcnt(0)
    v_mfma_f32_32x32x16_bf16 v[32:47], a[44:47], v[76:79], v[32:47]
    s_waitcnt vmcnt(8)
    ds_read_b128 a[48:51], v96 offset:0
    ds_read_b128 a[52:55], v97 offset:0
    ds_read_b128 a[56:59], v98 offset:0
    ds_read_b128 a[60:63], v99 offset:0
    ds_read_b64_tr_b16 v[48:49], v2 offset:24576
    ds_read_b64_tr_b16 v[50:51], v2 offset:25088
    ds_read_b64_tr_b16 v[52:53], v3 offset:24576
    ds_read_b64_tr_b16 v[54:55], v3 offset:25088
    ds_read_b64_tr_b16 v[56:57], v2 offset:26624
    ds_read_b64_tr_b16 v[58:59], v2 offset:27136
    ds_read_b64_tr_b16 v[60:61], v3 offset:26624
    ds_read_b64_tr_b16 v[62:63], v3 offset:27136
    s_waitcnt lgkmcnt(8)
    s_add_u32 m0, s52, 0
    s_mov_b32 s35, 768
    buffer_load_dwordx4 v7, s[8:11], s35 offen lds
    s_add_u32 m0, s52, 1024
    s_mov_b32 s35, 8960
    buffer_load_dwordx4 v15, s[8:11], s35 offen lds
    s_add_u32 m0, s52, 2048
    s_mov_b32 s35, 17152
    buffer_load_dwordx4 v7, s[8:11], s35 offen lds
    s_add_u32 m0, s52, 3072
    s_mov_b32 s35, 25344
    buffer_load_dwordx4 v15, s[8:11], s35 offen lds
    ds_read_b64_tr_b16 v[64:65], v2 offset:28672
    ds_read_b64_tr_b16 v[66:67], v2 offset:29184
    s_waitcnt lgkmcnt(8)
    v_mfma_f32_32x32x16_bf16 v[16:31], a[48:51], v[48:51], v[16:31]
    ds_read_b64_tr_b16 v[68:69], v3 offset:28672
    ds_read_b64_tr_b16 v[70:71], v3 offset:29184
    s_waitcnt lgkmcnt(8)
    v_mfma_f32_32x32x16_bf16 v[32:47], a[48:51], v[52:55], v[32:47]
    ds_read_b64_tr_b16 v[72:73], v2 offset:30720
    ds_read_b64_tr_b16 v[74:75], v2 offset:31232
    s_waitcnt lgkmcnt(8)
    v_mfma_f32_32x32x16_bf16 v[16:31], a[52:55], v[56:59], v[16:31]
    ds_read_b64_tr_b16 v[76:77], v3 offset:30720
    ds_read_b64_tr_b16 v[78:79], v3 offset:31232
    s_waitcnt lgkmcnt(8)
    v_mfma_f32_32x32x16_bf16 v[32:47], a[52:55], v[60:63], v[32:47]
    s_waitcnt lgkmcnt(6)
    v_mfma_f32_32x32x16_bf16 v[16:31], a[56:59], v[64:67], v[16:31]
    s_waitcnt lgkmcnt(4)
    v_mfma_f32_32x32x16_bf16 v[32:47], a[56:59], v[68:71], v[32:47]
    s_waitcnt lgkmcnt(2)
    v_mfma_f32_32x32x16_bf16 v[16:31], a[60:63], v[72:75], v[16:31]
    s_waitcnt lgkmcnt(0)
    v_mfma_f32_32x32x16_bf16 v[32:47], a[60:63], v[76:79], v[32:47]
    s_waitcnt vmcnt(8)
    s_barrier
    ds_read_b128 a[64:67], v96 offset:4096
    ds_read_b128 a[68:71], v97 offset:4096
    ds_read_b128 a[72:75], v98 offset:4096
    ds_read_b128 a[76:79], v99 offset:4096
    ds_read_b64_tr_b16 v[48:49], v2 offset:32768
    ds_read_b64_tr_b16 v[50:51], v2 offset:33280
    ds_read_b64_tr_b16 v[52:53], v3 offset:32768
    ds_read_b64_tr_b16 v[54:55], v3 offset:33280
    ds_read_b64_tr_b16 v[56:57], v2 offset:34816
    ds_read_b64_tr_b16 v[58:59], v2 offset:35328
    ds_read_b64_tr_b16 v[60:61], v3 offset:34816
    ds_read_b64_tr_b16 v[62:63], v3 offset:35328
    s_waitcnt lgkmcnt(8)
    s_add_u32 m0, s52, 4096
    s_mov_b32 s35, 896
    buffer_load_dwordx4 v7, s[8:11], s35 offen lds
    s_add_u32 m0, s52, 5120
    s_mov_b32 s35, 9088
    buffer_load_dwordx4 v15, s[8:11], s35 offen lds
    s_add_u32 m0, s52, 6144
    s_mov_b32 s35, 17280
    buffer_load_dwordx4 v7, s[8:11], s35 offen lds
    s_add_u32 m0, s52, 7168
    s_mov_b32 s35, 25472
    buffer_load_dwordx4 v15, s[8:11], s35 offen lds
    ds_read_b64_tr_b16 v[64:65], v2 offset:36864
    ds_read_b64_tr_b16 v[66:67], v2 offset:37376
    s_waitcnt lgkmcnt(8)
    v_mfma_f32_32x32x16_bf16 v[16:31], a[64:67], v[48:51], v[16:31]
    ds_read_b64_tr_b16 v[68:69], v3 offset:36864
    ds_read_b64_tr_b16 v[70:71], v3 offset:37376
    s_waitcnt lgkmcnt(8)
    v_mfma_f32_32x32x16_bf16 v[32:47], a[64:67], v[52:55], v[32:47]
    ds_read_b64_tr_b16 v[72:73], v2 offset:38912
    ds_read_b64_tr_b16 v[74:75], v2 offset:39424
    s_waitcnt lgkmcnt(8)
    v_mfma_f32_32x32x16_bf16 v[16:31], a[68:71], v[56:59], v[16:31]
    ds_read_b64_tr_b16 v[76:77], v3 offset:38912
    ds_read_b64_tr_b16 v[78:79], v3 offset:39424
    s_waitcnt lgkmcnt(8)
    v_mfma_f32_32x32x16_bf16 v[32:47], a[68:71], v[60:63], v[32:47]
    s_waitcnt lgkmcnt(6)
    v_mfma_f32_32x32x16_bf16 v[16:31], a[72:75], v[64:67], v[16:31]
    s_waitcnt lgkmcnt(4)
    v_mfma_f32_32x32x16_bf16 v[32:47], a[72:75], v[68:71], v[32:47]
    s_waitcnt lgkmcnt(2)
    v_mfma_f32_32x32x16_bf16 v[16:31], a[76:79], v[72:75], v[16:31]
    s_waitcnt lgkmcnt(0)
    v_mfma_f32_32x32x16_bf16 v[32:47], a[76:79], v[76:79], v[32:47]
    s_waitcnt vmcnt(8)
    ds_read_b128 a[80:83], v96 offset:8192
    ds_read_b128 a[84:87], v97 offset:8192
    ds_read_b128 a[88:91], v98 offset:8192
    ds_read_b128 a[92:95], v99 offset:8192
    ds_read_b64_tr_b16 v[48:49], v2 offset:40960
    ds_read_b64_tr_b16 v[50:51], v2 offset:41472
    ds_read_b64_tr_b16 v[52:53], v3 offset:40960
    ds_read_b64_tr_b16 v[54:55], v3 offset:41472
    ds_read_b64_tr_b16 v[56:57], v2 offset:43008
    ds_read_b64_tr_b16 v[58:59], v2 offset:43520
    ds_read_b64_tr_b16 v[60:61], v3 offset:43008
    ds_read_b64_tr_b16 v[62:63], v3 offset:43520
    s_waitcnt lgkmcnt(8)
    ds_read_b64_tr_b16 v[64:65], v2 offset:45056
    ds_read_b64_tr_b16 v[66:67], v2 offset:45568
    s_waitcnt lgkmcnt(8)
    v_mfma_f32_32x32x16_bf16 v[16:31], a[80:83], v[48:51], v[16:31]
    ds_read_b64_tr_b16 v[68:69], v3 offset:45056
    ds_read_b64_tr_b16 v[70:71], v3 offset:45568
    s_waitcnt lgkmcnt(8)
    v_mfma_f32_32x32x16_bf16 v[32:47], a[80:83], v[52:55], v[32:47]
    ds_read_b64_tr_b16 v[72:73], v2 offset:47104
    ds_read_b64_tr_b16 v[74:75], v2 offset:47616
    s_waitcnt lgkmcnt(8)
    v_mfma_f32_32x32x16_bf16 v[16:31], a[84:87], v[56:59], v[16:31]
    ds_read_b64_tr_b16 v[76:77], v3 offset:47104
    ds_read_b64_tr_b16 v[78:79], v3 offset:47616
    s_waitcnt lgkmcnt(8)
    v_mfma_f32_32x32x16_bf16 v[32:47], a[84:87], v[60:63], v[32:47]
    s_waitcnt lgkmcnt(6)
    v_mfma_f32_32x32x16_bf16 v[16:31], a[88:91], v[64:67], v[16:31]
    s_waitcnt lgkmcnt(4)
    v_mfma_f32_32x32x16_bf16 v[32:47], a[88:91], v[68:71], v[32:47]
    s_waitcnt lgkmcnt(2)
    v_mfma_f32_32x32x16_bf16 v[16:31], a[92:95], v[72:75], v[16:31]
    s_waitcnt lgkmcnt(0)
    v_mfma_f32_32x32x16_bf16 v[32:47], a[92:95], v[76:79], v[32:47]
    s_waitcnt vmcnt(4)
    ds_read_b128 a[96:99], v96 offset:0
    ds_read_b128 a[100:103], v97 offset:0
    ds_read_b128 a[104:107], v98 offset:0
    ds_read_b128 a[108:111], v99 offset:0
    ds_read_b64_tr_b16 v[48:49], v2 offset:49152
    ds_read_b64_tr_b16 v[50:51], v2 offset:49664
    ds_read_b64_tr_b16 v[52:53], v3 offset:49152
    ds_read_b64_tr_b16 v[54:55], v3 offset:49664
    ds_read_b64_tr_b16 v[56:57], v2 offset:51200
    ds_read_b64_tr_b16 v[58:59], v2 offset:51712
    ds_read_b64_tr_b16 v[60:61], v3 offset:51200
    ds_read_b64_tr_b16 v[62:63], v3 offset:51712
    s_waitcnt lgkmcnt(8)
    ds_read_b64_tr_b16 v[64:65], v2 offset:53248
    ds_read_b64_tr_b16 v[66:67], v2 offset:53760
    s_waitcnt lgkmcnt(8)
    v_mfma_f32_32x32x16_bf16 v[16:31], a[96:99], v[48:51], v[16:31]
    ds_read_b64_tr_b16 v[68:69], v3 offset:53248
    ds_read_b64_tr_b16 v[70:71], v3 offset:53760
    s_waitcnt lgkmcnt(8)
    v_mfma_f32_32x32x16_bf16 v[32:47], a[96:99], v[52:55], v[32:47]
    ds_read_b64_tr_b16 v[72:73], v2 offset:55296
    ds_read_b64_tr_b16 v[74:75], v2 offset:55808
    s_waitcnt lgkmcnt(8)
    v_mfma_f32_32x32x16_bf16 v[16:31], a[100:103], v[56:59], v[16:31]
    ds_read_b64_tr_b16 v[76:77], v3 offset:55296
    ds_read_b64_tr_b16 v[78:79], v3 offset:55808
    s_waitcnt lgkmcnt(8)
    v_mfma_f32_32x32x16_bf16 v[32:47], a[100:103], v[60:63], v[32:47]
    s_waitcnt lgkmcnt(6)
    v_mfma_f32_32x32x16_bf16 v[16:31], a[104:107], v[64:67], v[16:31]
    s_waitcnt lgkmcnt(4)
    v_mfma_f32_32x32x16_bf16 v[32:47], a[104:107], v[68:71], v[32:47]
    s_waitcnt lgkmcnt(2)
    v_mfma_f32_32x32x16_bf16 v[16:31], a[108:111], v[72:75], v[16:31]
    s_waitcnt lgkmcnt(0)
    v_mfma_f32_32x32x16_bf16 v[32:47], a[108:111], v[76:79], v[32:47]
    s_waitcnt vmcnt(0)
    ds_read_b128 a[112:115], v96 offset:4096
    ds_read_b128 a[116:119], v97 offset:4096
    ds_read_b128 a[120:123], v98 offset:4096
    ds_read_b128 a[124:127], v99 offset:4096
    ds_read_b64_tr_b16 v[48:49], v2 offset:57344
    ds_read_b64_tr_b16 v[50:51], v2 offset:57856
    ds_read_b64_tr_b16 v[52:53], v3 offset:57344
    ds_read_b64_tr_b16 v[54:55], v3 offset:57856
    ds_read_b64_tr_b16 v[56:57], v2 offset:59392
    ds_read_b64_tr_b16 v[58:59], v2 offset:59904
    ds_read_b64_tr_b16 v[60:61], v3 offset:59392
    ds_read_b64_tr_b16 v[62:63], v3 offset:59904
    s_waitcnt lgkmcnt(8)
    ds_read_b64_tr_b16 v[64:65], v2 offset:61440
    ds_read_b64_tr_b16 v[66:67], v2 offset:61952
    s_waitcnt lgkmcnt(8)
    v_mfma_f32_32x32x16_bf16 v[16:31], a[112:115], v[48:51], v[16:31]
    ds_read_b64_tr_b16 v[68:69], v3 offset:61440
    ds_read_b64_tr_b16 v[70:71], v3 offset:61952
    s_waitcnt lgkmcnt(8)
    v_mfma_f32_32x32x16_bf16 v[32:47], a[112:115], v[52:55], v[32:47]
    ds_read_b64_tr_b16 v[72:73], v2 offset:63488
    ds_read_b64_tr_b16 v[74:75], v2 offset:64000
    s_waitcnt lgkmcnt(8)
    v_mfma_f32_32x32x16_bf16 v[16:31], a[116:119], v[56:59], v[16:31]
    ds_read_b64_tr_b16 v[76:77], v3 offset:63488
    ds_read_b64_tr_b16 v[78:79], v3 offset:64000
    s_waitcnt lgkmcnt(8)
    v_mfma_f32_32x32x16_bf16 v[32:47], a[116:119], v[60:63], v[32:47]
    s_waitcnt lgkmcnt(6)
    v_mfma_f32_32x32x16_bf16 v[16:31], a[120:123], v[64:67], v[16:31]
    s_waitcnt lgkmcnt(4)
    v_mfma_f32_32x32x16_bf16 v[32:47], a[120:123], v[68:71], v[32:47]
    s_waitcnt lgkmcnt(2)
    v_mfma_f32_32x32x16_bf16 v[16:31], a[124:127], v[72:75], v[16:31]
    s_waitcnt lgkmcnt(0)
    v_mfma_f32_32x32x16_bf16 v[32:47], a[124:127], v[76:79], v[32:47]
    s_barrier
    s_lshr_b32 s28, s53, 1
    s_mul_i32 s27, s28, s68
    s_add_u32 s27, s27, s67
    s_cmp_ge_u32 s28, s64
    s_cselect_b32 s27, s69, s27
    s_cmp_ge_u32 s27, 128
    s_cselect_b32 s12, s20, s12
    s_cselect_b32 s13, s21, s13
    s_and_b32 s27, s27, 127
    s_lshl_b32 s54, s27, 6
    s_and_b32 s27, s53, 1
    s_lshl_b32 s27, s27, 21
    s_add_u32 s54, s54, s27
    s_and_b32 s27, s53, 3
    s_lshl_b32 s27, s27, 15
    s_add_u32 s55, s27, s34
    s_add_u32 s53, s53, 1
    s_add_u32 m0, s55, 0
    s_add_u32 s35, s54, 0
    buffer_load_dwordx4 v4, s[12:15], s35 offen lds
    s_add_u32 m0, s55, 1024
    s_add_u32 s35, s54, 65536
    buffer_load_dwordx4 v4, s[12:15], s35 offen lds
    s_add_u32 m0, s55, 2048
    s_add_u32 s35, s54, 131072
    buffer_load_dwordx4 v4, s[12:15], s35 offen lds
    s_add_u32 m0, s55, 3072
    s_add_u32 s35, s54, 196608
    buffer_load_dwordx4 v4, s[12:15], s35 offen lds
    s_lshr_b32 s28, s53, 1
    s_mul_i32 s27, s28, s68
    s_add_u32 s27, s27, s67
    s_cmp_ge_u32 s28, s64
    s_cselect_b32 s27, s69, s27
    s_cmp_ge_u32 s27, 128
    s_cselect_b32 s12, s20, s12
    s_cselect_b32 s13, s21, s13
    s_and_b32 s27, s27, 127
    s_lshl_b32 s54, s27, 6
    s_and_b32 s27, s53, 1
    s_lshl_b32 s27, s27, 21
    s_add_u32 s54, s54, s27
    s_and_b32 s27, s53, 3
    s_lshl_b32 s27, s27, 15
    s_add_u32 s55, s27, s34
    s_add_u32 s53, s53, 1
    s_add_u32 m0, s55, 0
    s_add_u32 s35, s54, 0
    buffer_load_dwordx4 v4, s[12:15], s35 offen lds
    s_add_u32 m0, s55, 1024
    s_add_u32 s35, s54, 65536
    buffer_load_dwordx4 v4, s[12:15], s35 offen lds
    s_add_u32 m0, s55, 2048
    s_add_u32 s35, s54, 131072
    buffer_load_dwordx4 v4, s[12:15], s35 offen lds
    s_add_u32 m0, s55, 3072
    s_add_u32 s35, s54, 196608
    buffer_load_dwordx4 v4, s[12:15], s35 offen lds
    v_mul_f32 v16, s77, v16
    v_mul_f32 v17, s77, v17
    v_mul_f32 v18, s77, v18
    v_mul_f32 v19, s77, v19
    v_mul_f32 v20, s77, v20
    v_mul_f32 v21, s77, v21
    v_mul_f32 v22, s77, v22
    v_mul_f32 v23, s77, v23
    v_cvt_pk_bf16_f32 v80, v16, v17
    v_cvt_pk_bf16_f32 v81, v18, v19
    v_cvt_pk_bf16_f32 v82, v20, v21
    v_cvt_pk_bf16_f32 v83, v22, v23
    buffer_store_dwordx4 v[80:83], v5, s[16:19], s50 offen sc0 sc1
    v_mul_f32 v24, s77, v24
    v_mul_f32 v25, s77, v25
    v_mul_f32 v26, s77, v26
    v_mul_f32 v27, s77, v27
    v_mul_f32 v28, s77, v28
    v_mul_f32 v29, s77, v29
    v_mul_f32 v30, s77, v30
    v_mul_f32 v31, s77, v31
    v_cvt_pk_bf16_f32 v84, v24, v25
    v_cvt_pk_bf16_f32 v85, v26, v27
    v_cvt_pk_bf16_f32 v86, v28, v29
    v_cvt_pk_bf16_f32 v87, v30, v31
    buffer_store_dwordx4 v[84:87], v6, s[16:19], s50 offen sc0 sc1
    v_mov_b32 v8, v6
    s_mov_b32 s33, s51
qkv_kernel_firstd:
    s_lshr_b32 s28, s53, 1
    s_mul_i32 s27, s28, s68
    s_add_u32 s27, s27, s67
    s_cmp_ge_u32 s28, s64
    s_cselect_b32 s27, s69, s27
    s_cmp_ge_u32 s27, 128
    s_cselect_b32 s12, s20, s12
    s_cselect_b32 s13, s21, s13
    s_and_b32 s27, s27, 127
    s_lshl_b32 s54, s27, 6
    s_and_b32 s27, s53, 1
    s_lshl_b32 s27, s27, 21
    s_add_u32 s54, s54, s27
    s_and_b32 s27, s53, 3
    s_lshl_b32 s27, s27, 15
    s_add_u32 s55, s27, s34
    s_add_u32 s53, s53, 1
    s_add_u32 m0, s55, 0
    s_add_u32 s35, s54, 0
    buffer_load_dwordx4 v4, s[12:15], s35 offen lds
    s_add_u32 m0, s55, 1024
    s_add_u32 s35, s54, 65536
    buffer_load_dwordx4 v4, s[12:15], s35 offen lds
    s_add_u32 m0, s55, 2048
    s_add_u32 s35, s54, 131072
    buffer_load_dwordx4 v4, s[12:15], s35 offen lds
    s_add_u32 m0, s55, 3072
    s_add_u32 s35, s54, 196608
    buffer_load_dwordx4 v4, s[12:15], s35 offen lds
    s_mov_b32 s27, 0x10000000
    buffer_store_dwordx4 v[80:83], v5, s[16:19], s27 offen
    s_mov_b32 s72, s62
    s_and_b32 s73, s63, 0xffff
    s_mov_b32 s74, 4194304
    s_mov_b32 s75, 0x00020000
    s_lshl_b32 s27, s2, 3
    s_add_u32 s27, s27, s24
    s_and_b32 s28, s27, 255
    s_lshr_b32 s27, s27, 8
    s_lshl_b32 s28, s28, 14
    s_lshl_b32 s27, s27, 7
    s_add_u32 s27, s27, s28
    v_and_b32 v120, 15, v1
    v_lshlrev_b32 v120, 10, v120
    buffer_load_dword v121, v120, s[72:75], s27 offen
    v_xor_b32 v2, 0x10000, v2
    v_xor_b32 v3, 0x10000, v3
    s_add_u32 s66, s66, 1
    s_add_u32 s30, s30, s68
    s_cmp_ge_u32 s66, s64
    s_cselect_b32 s30, s69, s30
    s_lshr_b32 s28, s53, 1
    s_mul_i32 s27, s28, s68
    s_add_u32 s27, s27, s67
    s_cmp_ge_u32 s28, s64
    s_cselect_b32 s27, s69, s27
    s_cmp_ge_u32 s27, 128
    s_cselect_b32 s12, s20, s12
    s_cselect_b32 s13, s21, s13
    s_and_b32 s27, s27, 127
    s_lshl_b32 s54, s27, 6
    s_and_b32 s27, s53, 1
    s_lshl_b32 s27, s27, 21
    s_add_u32 s54, s54, s27
    s_and_b32 s27, s53, 3
    s_lshl_b32 s27, s27, 15
    s_add_u32 s55, s27, s34
    s_add_u32 s53, s53, 1
    s_waitcnt vmcnt(12)
    s_barrier
    ds_read_b64_tr_b16 v[48:49], v2 offset:0
    ds_read_b64_tr_b16 v[50:51], v2 offset:512
    ds_read_b64_tr_b16 v[52:53], v2 offset:2048
    ds_read_b64_tr_b16 v[54:55], v2 offset:2560
    ds_read_b64_tr_b16 v[56:57], v2 offset:4096
    ds_read_b64_tr_b16 v[58:59], v2 offset:4608
    ds_read_b64_tr_b16 v[60:61], v2 offset:6144
    ds_read_b64_tr_b16 v[62:63], v2 offset:6656
    ds_read_b64_tr_b16 v[64:65], v2 offset:8192
    ds_read_b64_tr_b16 v[66:67], v2 offset:8704
    ds_read_b64_tr_b16 v[68:69], v2 offset:10240
    ds_read_b64_tr_b16 v[70:71], v2 offset:10752
qkv_kernel_loop:
    v_xor_b32 v100, 0x10000, v2
    v_xor_b32 v101, 0x10000, v3
    s_cmp_ge_u32 s30, 128
    s_cbranch_scc1 qkv_kernel_bodyV
    s_cmp_ge_u32 s66, s64
    s_cbranch_scc1 qkv_kernel_bodyH
    s_waitcnt vmcnt(8)
    s_barrier
    ds_read_b64_tr_b16 v[72:73], v2 offset:12288
    ds_read_b64_tr_b16 v[74:75], v2 offset:12800
    s_waitcnt lgkmcnt(12)
    v_mfma_f32_32x32x16_bf16 v[16:31], v[48:51], a[0:3], 0
    ds_read_b64_tr_b16 v[76:77], v2 offset:14336
    ds_read_b64_tr_b16 v[78:79], v2 offset:14848
    s_waitcnt lgkmcnt(12)
    v_mfma_f32_32x32x16_bf16 v[16:31], v[52:55], a[4:7], v[16:31]
    s_add_u32 m0, s55, 0
    s_add_u32 s35, s54, 0
    buffer_load_dwordx4 v4, s[12:15], s35 offen lds
    ds_read_b64_tr_b16 v[48:49], v2 offset:16384
    ds_read_b64_tr_b16 v[50:51], v2 offset:16896
    s_waitcnt lgkmcnt(12)
    v_mfma_f32_32x32x16_bf16 v[16:31], v[56:59], a[8:11], v[16:31]
    ds_read_b64_tr_b16 v[52:53], v2 offset:18432
    ds_read_b64_tr_b16 v[54:55], v2 offset:18944
    s_waitcnt lgkmcnt(12)
    v_mfma_f32_32x32x16_bf16 v[16:31], v[60:63], a[12:15], v[16:31]
    s_add_u32 m0, s55, 1024
    s_add_u32 s35, s54, 65536
    buffer_load_dwordx4 v4, s[12:15], s35 offen lds
    ds_read_b64_tr_b16 v[56:57], v2 offset:20480
    ds_read_b64_tr_b16 v[58:59], v2 offset:20992
    s_waitcnt lgkmcnt(12)
    v_mfma_f32_32x32x16_bf16 v[16:31], v[64:67], a[16:19], v[16:31]
    ds_read_b64_tr_b16 v[60:61], v2 offset:22528
    ds_read_b64_tr_b16 v[62:63], v2 offset:23040
    s_waitcnt lgkmcnt(12)
    v_mfma_f32_32x32x16_bf16 v[16:31], v[68:71], a[20:23], v[16:31]
    s_add_u32 m0, s55, 2048
    s_add_u32 s35, s54, 131072
    buffer_load_dwordx4 v4, s[12:15], s35 offen lds
    ds_read_b64_tr_b16 v[64:65], v2 offset:24576
    ds_read_b64_tr_b16 v[66:67], v2 offset:25088
    s_waitcnt lgkmcnt(12)
    v_mfma_f32_32x32x16_bf16 v[16:31], v[72:75], a[24:27], v[16:31]
    ds_read_b64_tr_b16 v[68:69], v2 offset:26624
    ds_read_b64_tr_b16 v[70:71], v2 offset:27136
    s_waitcnt lgkmcnt(12)
    v_mfma_f32_32x32x16_bf16 v[16:31], v[76:79], a[28:31], v[16:31]
    s_add_u32 m0, s55, 3072
    s_add_u32 s35, s54, 196608
    buffer_load_dwordx4 v4, s[12:15], s35 offen lds
    ds_read_b64_tr_b16 v[72:73], v2 offset:28672
    ds_read_b64_tr_b16 v[74:75], v2 offset:29184
    s_waitcnt lgkmcnt(12)
    v_mfma_f32_32x32x16_bf16 v[16:31], v[48:51], a[32:35], v[16:31]
    v_mul_f32 v32, s77, v32
    v_mul_f32 v33, s77, v33
    v_mul_f32 v34, s77, v34
    v_mul_f32 v35, s77, v35
    ds_read_b64_tr_b16 v[76:77], v2 offset:30720
    ds_read_b64_tr_b16 v[78:79], v2 offset:31232
    s_waitcnt lgkmcnt(12)
    v_mfma_f32_32x32x16_bf16 v[16:31], v[52:55], a[36:39], v[16:31]
    v_mul_f32 v36, s77, v36
    v_mul_f32 v37, s77, v37
    v_mul_f32 v38, s77, v38
    v_mul_f32 v39, s77, v39
    ds_read_b64_tr_b16 v[48:49], v3 offset:0
    ds_read_b64_tr_b16 v[50:51], v3 offset:512
    s_waitcnt lgkmcnt(12)
    v_mfma_f32_32x32x16_bf16 v[16:31], v[56:59], a[40:43], v[16:31]
    v_cvt_pk_bf16_f32 v88, v32, v33
    v_cvt_pk_bf16_f32 v89, v34, v35
    v_cvt_pk_bf16_f32 v90, v36, v37
    v_cvt_pk_bf16_f32 v91, v38, v39
    ds_read_b64_tr_b16 v[52:53], v3 offset:2048
    ds_read_b64_tr_b16 v[54:55], v3 offset:2560
    s_waitcnt lgkmcnt(12)
    v_mfma_f32_32x32x16_bf16 v[16:31], v[60:63], a[44:47], v[16:31]
    buffer_store_dwordx4 v[88:91], v5, s[16:19], s33 offen sc0 sc1
    v_mul_f32 v40, s77, v40
    v_mul_f32 v41, s77, v41
    v_mul_f32 v42, s77, v42
    ds_read_b64_tr_b16 v[56:57], v3 offset:4096
    ds_read_b64_tr_b16 v[58:59], v3 offset:4608
    s_waitcnt lgkmcnt(12)
    v_mfma_f32_32x32x16_bf16 v[16:31], v[64:67], a[48:51], v[16:31]
    v_mul_f32 v43, s77, v43
    v_mul_f32 v44, s77, v44
    v_mul_f32 v45, s77, v45
    v_mul_f32 v46, s77, v46
    ds_read_b64_tr_b16 v[60:61], v3 offset:6144
    ds_read_b64_tr_b16 v[62:63], v3 offset:6656
    s_waitcnt lgkmcnt(12)
    v_mfma_f32_32x32x16_bf16 v[16:31], v[68:71], a[52:55], v[16:31]
    v_mul_f32 v47, s77, v47
    v_cvt_pk_bf16_f32 v92, v40, v41
    v_cvt_pk_bf16_f32 v93, v42, v43
    v_cvt_pk_bf16_f32 v94, v44, v45
    ds_read_b64_tr_b16 v[64:65], v3 offset:8192
    ds_read_b64_tr_b16 v[66:67], v3 offset:8704
    s_waitcnt lgkmcnt(12)
    v_mfma_f32_32x32x16_bf16 v[16:31], v[72:75], a[56:59], v[16:31]
    s_and_b32 s49, s30, 127
    s_lshl_b32 s49, s49, 5
    v_cvt_pk_bf16_f32 v95, v46, v47
    buffer_store_dwordx4 v[92:95], v8, s[16:19], s33 offen sc0 sc1
    ds_read_b64_tr_b16 v[68:69], v3 offset:10240
    ds_read_b64_tr_b16 v[70:71], v3 offset:10752
    s_waitcnt lgkmcnt(12)
    v_mfma_f32_32x32x16_bf16 v[16:31], v[76:79], a[60:63], v[16:31]
    s_add_u32 s28, s49, 0
    s_lshr_b32 s50, s28, 7
    ds_read_b64_tr_b16 v[72:73], v3 offset:12288
    ds_read_b64_tr_b16 v[74:75], v3 offset:12800
    s_waitcnt lgkmcnt(12)
    v_mfma_f32_32x32x16_bf16 v[32:47], v[48:51], a[0:3], 0
    s_lshl_b32 s50, s50, 19
    s_and_b32 s28, s28, 127
    ds_read_b64_tr_b16 v[76:77], v3 offset:14336
    ds_read_b64_tr_b16 v[78:79], v3 offset:14848
    s_waitcnt lgkmcnt(12)
    v_mfma_f32_32x32x16_bf16 v[32:47], v[52:55], a[4:7], v[32:47]
    s_lshl_b32 s28, s28, 6
    s_add_u32 s50, s50, s28
    ds_read_b64_tr_b16 v[48:49], v3 offset:16384
    ds_read_b64_tr_b16 v[50:51], v3 offset:16896
    s_waitcnt lgkmcnt(12)
    v_mfma_f32_32x32x16_bf16 v[32:47], v[56:59], a[8:11], v[32:47]
    s_add_u32 s50, s50, s29
    s_add_u32 s28, s49, 32
    ds_read_b64_tr_b16 v[52:53], v3 offset:18432
    ds_read_b64_tr_b16 v[54:55], v3 offset:18944
    s_waitcnt lgkmcnt(12)
    v_mfma_f32_32x32x16_bf16 v[32:47], v[60:63], a[12:15], v[32:47]
    s_lshr_b32 s51, s28, 7
    s_lshl_b32 s51, s51, 19
    ds_read_b64_tr_b16 v[56:57], v3 offset:20480
    ds_read_b64_tr_b16 v[58:59], v3 offset:20992
    s_waitcnt lgkmcnt(12)
    v_mfma_f32_32x32x16_bf16 v[32:47], v[64:67], a[16:19], v[32:47]
    s_and_b32 s28, s28, 127
    s_lshl_b32 s28, s28, 6
    ds_read_b64_tr_b16 v[60:61], v3 offset:22528
    ds_read_b64_tr_b16 v[62:63], v3 offset:23040
    s_waitcnt lgkmcnt(12)
    v_mfma_f32_32x32x16_bf16 v[32:47], v[68:71], a[20:23], v[32:47]
    s_add_u32 s51, s51, s28
    s_add_u32 s51, s51, s29
    ds_read_b64_tr_b16 v[64:65], v3 offset:24576
    ds_read_b64_tr_b16 v[66:67], v3 offset:25088
    s_waitcnt lgkmcnt(12)
    v_mfma_f32_32x32x16_bf16 v[32:47], v[72:75], a[24:27], v[32:47]
    ds_read_b64_tr_b16 v[68:69], v3 offset:26624
    ds_read_b64_tr_b16 v[70:71], v3 offset:27136
    s_waitcnt lgkmcnt(12)
    v_mfma_f32_32x32x16_bf16 v[32:47], v[76:79], a[28:31], v[32:47]
    ds_read_b64_tr_b16 v[72:73], v3 offset:28672
    ds_read_b64_tr_b16 v[74:75], v3 offset:29184
    s_waitcnt lgkmcnt(12)
    v_mfma_f32_32x32x16_bf16 v[32:47], v[48:51], a[32:35], v[32:47]
    ds_read_b64_tr_b16 v[76:77], v3 offset:30720
    ds_read_b64_tr_b16 v[78:79], v3 offset:31232
    s_waitcnt lgkmcnt(12)
    v_mfma_f32_32x32x16_bf16 v[32:47], v[52:55], a[36:39], v[32:47]
    ds_read_b64_tr_b16 v[48:49], v2 offset:32768
    ds_read_b64_tr_b16 v[50:51], v2 offset:33280
    s_waitcnt lgkmcnt(12)
    v_mfma_f32_32x32x16_bf16 v[32:47], v[56:59], a[40:43], v[32:47]
    ds_read_b64_tr_b16 v[52:53], v2 offset:34816
    ds_read_b64_tr_b16 v[54:55], v2 offset:35328
    s_waitcnt lgkmcnt(12)
    v_mfma_f32_32x32x16_bf16 v[32:47], v[60:63], a[44:47], v[32:47]
    ds_read_b64_tr_b16 v[56:57], v2 offset:36864
    ds_read_b64_tr_b16 v[58:59], v2 offset:37376
    s_waitcnt lgkmcnt(12)
    v_mfma_f32_32x32x16_bf16 v[32:47], v[64:67], a[48:51], v[32:47]
    ds_read_b64_tr_b16 v[60:61], v2 offset:38912
    ds_read_b64_tr_b16 v[62:63], v2 offset:39424
    s_waitcnt lgkmcnt(12)
    v_mfma_f32_32x32x16_bf16 v[32:47], v[68:71], a[52:55], v[32:47]
    s_lshr_b32 s28, s53, 1
    s_mul_i32 s27, s28, s68
    s_add_u32 s27, s27, s67
    s_cmp_ge_u32 s28, s64
    s_cselect_b32 s27, s69, s27
    s_cmp_ge_u32 s27, 128
    s_cselect_b32 s12, s20, s12
    s_cselect_b32 s13, s21, s13
    s_and_b32 s27, s27, 127
    s_lshl_b32 s54, s27, 6
    s_and_b32 s27, s53, 1
    s_lshl_b32 s27, s27, 21
    s_add_u32 s54, s54, s27
    s_and_b32 s27, s53, 3
    s_lshl_b32 s27, s27, 15
    s_add_u32 s55, s27, s34
    s_add_u32 s53, s53, 1
    ds_read_b64_tr_b16 v[64:65], v2 offset:40960
    ds_read_b64_tr_b16 v[66:67], v2 offset:41472
    s_waitcnt lgkmcnt(12)
    v_mfma_f32_32x32x16_bf16 v[32:47], v[72:75], a[56:59], v[32:47]
    ds_read_b64_tr_b16 v[68:69], v2 offset:43008
    ds_read_b64_tr_b16 v[70:71], v2 offset:43520
    s_waitcnt lgkmcnt(12)
    v_mfma_f32_32x32x16_bf16 v[32:47], v[76:79], a[60:63], v[32:47]
    s_waitcnt vmcnt(8)
    s_barrier
    ds_read_b64_tr_b16 v[72:73], v2 offset:45056
    ds_read_b64_tr_b16 v[74:75], v2 offset:45568
    s_waitcnt lgkmcnt(12)
    v_mfma_f32_32x32x16_bf16 v[16:31], v[48:51], a[64:67], v[16:31]
    ds_read_b64_tr_b16 v[76:77], v2 offset:47104
    ds_read_b64_tr_b16 v[78:79], v2 offset:47616
    s_waitcnt lgkmcnt(12)
    v_mfma_f32_32x32x16_bf16 v[16:31], v[52:55], a[68:71], v[16:31]
    s_add_u32 m0, s55, 0
    s_add_u32 s35, s54, 0
    buffer_load_dwordx4 v4, s[12:15], s35 offen lds
    ds_read_b64_tr_b16 v[48:49], v2 offset:49152
    ds_read_b64_tr_b16 v[50:51], v2 offset:49664
    s_waitcnt lgkmcnt(12)
    v_mfma_f32_32x32x16_bf16 v[16:31], v[56:59], a[72:75], v[16:31]
    ds_read_b64_tr_b16 v[52:53], v2 offset:51200
    ds_read_b64_tr_b16 v[54:55], v2 offset:51712
    s_waitcnt lgkmcnt(12)
    v_mfma_f32_32x32x16_bf16 v[16:31], v[60:63], a[76:79], v[16:31]
    s_add_u32 m0, s55, 1024
    s_add_u32 s35, s54, 65536
    buffer_load_dwordx4 v4, s[12:15], s35 offen lds
    ds_read_b64_tr_b16 v[56:57], v2 offset:53248
    ds_read_b64_tr_b16 v[58:59], v2 offset:53760
    s_waitcnt lgkmcnt(12)
    v_mfma_f32_32x32x16_bf16 v[16:31], v[64:67], a[80:83], v[16:31]
    ds_read_b64_tr_b16 v[60:61], v2 offset:55296
    ds_read_b64_tr_b16 v[62:63], v2 offset:55808
    s_waitcnt lgkmcnt(12)
    v_mfma_f32_32x32x16_bf16 v[16:31], v[68:71], a[84:87], v[16:31]
    s_add_u32 m0, s55, 2048
    s_add_u32 s35, s54, 131072
    buffer_load_dwordx4 v4, s[12:15], s35 offen lds
    ds_read_b64_tr_b16 v[64:65], v2 offset:57344
    ds_read_b64_tr_b16 v[66:67], v2 offset:57856
    s_waitcnt lgkmcnt(12)
    v_mfma_f32_32x32x16_bf16 v[16:31], v[72:75], a[88:91], v[16:31]
    ds_read_b64_tr_b16 v[68:69], v2 offset:59392
    ds_read_b64_tr_b16 v[70:71], v2 offset:59904
    s_waitcnt lgkmcnt(12)
    v_mfma_f32_32x32x16_bf16 v[16:31], v[76:79], a[92:95], v[16:31]
    s_add_u32 m0, s55, 3072
    s_add_u32 s35, s54, 196608
    buffer_load_dwordx4 v4, s[12:15], s35 offen lds
    ds_read_b64_tr_b16 v[72:73], v2 offset:61440
    ds_read_b64_tr_b16 v[74:75], v2 offset:61952
    s_waitcnt lgkmcnt(12)
    v_mfma_f32_32x32x16_bf16 v[16:31], v[48:51], a[96:99], v[16:31]
    ds_read_b64_tr_b16 v[76:77], v2 offset:63488
    ds_read_b64_tr_b16 v[78:79], v2 offset:64000
    s_waitcnt lgkmcnt(12)
    v_mfma_f32_32x32x16_bf16 v[16:31], v[52:55], a[100:103], v[16:31]
    ds_read_b64_tr_b16 v[48:49], v3 offset:32768
    ds_read_b64_tr_b16 v[50:51], v3 offset:33280
    s_waitcnt lgkmcnt(12)
    v_mfma_f32_32x32x16_bf16 v[16:31], v[56:59], a[104:107], v[16:31]
    ds_read_b64_tr_b16 v[52:53], v3 offset:34816
    ds_read_b64_tr_b16 v[54:55], v3 offset:35328
    s_waitcnt lgkmcnt(12)
    v_mfma_f32_32x32x16_bf16 v[16:31], v[60:63], a[108:111], v[16:31]
    ds_read_b64_tr_b16 v[56:57], v3 offset:36864
    ds_read_b64_tr_b16 v[58:59], v3 offset:37376
    s_waitcnt lgkmcnt(12)
    v_mfma_f32_32x32x16_bf16 v[16:31], v[64:67], a[112:115], v[16:31]
    ds_read_b64_tr_b16 v[60:61], v3 offset:38912
    ds_read_b64_tr_b16 v[62:63], v3 offset:39424
    s_waitcnt lgkmcnt(12)
    v_mfma_f32_32x32x16_bf16 v[16:31], v[68:71], a[116:119], v[16:31]
    ds_read_b64_tr_b16 v[64:65], v3 offset:40960
    ds_read_b64_tr_b16 v[66:67], v3 offset:41472
    s_waitcnt lgkmcnt(12)
    v_mfma_f32_32x32x16_bf16 v[16:31], v[72:75], a[120:123], v[16:31]
    ds_read_b64_tr_b16 v[68:69], v3 offset:43008
    ds_read_b64_tr_b16 v[70:71], v3 offset:43520
    s_waitcnt lgkmcnt(12)
    v_mfma_f32_32x32x16_bf16 v[16:31], v[76:79], a[124:127], v[16:31]
    ds_read_b64_tr_b16 v[72:73], v3 offset:45056
    ds_read_b64_tr_b16 v[74:75], v3 offset:45568
    s_waitcnt lgkmcnt(12)
    v_mfma_f32_32x32x16_bf16 v[32:47], v[48:51], a[64:67], v[32:47]
    ds_read_b64_tr_b16 v[76:77], v3 offset:47104
    ds_read_b64_tr_b16 v[78:79], v3 offset:47616
    s_waitcnt lgkmcnt(12)
    v_mfma_f32_32x32x16_bf16 v[32:47], v[52:55], a[68:71], v[32:47]
    ds_read_b64_tr_b16 v[48:49], v3 offset:49152
    ds_read_b64_tr_b16 v[50:51], v3 offset:49664
    s_waitcnt lgkmcnt(12)
    v_mfma_f32_32x32x16_bf16 v[32:47], v[56:59], a[72:75], v[32:47]
    ds_read_b64_tr_b16 v[52:53], v3 offset:51200
    ds_read_b64_tr_b16 v[54:55], v3 offset:51712
    s_waitcnt lgkmcnt(12)
    v_mfma_f32_32x32x16_bf16 v[32:47], v[60:63], a[76:79], v[32:47]
    ds_read_b64_tr_b16 v[56:57], v3 offset:53248
    ds_read_b64_tr_b16 v[58:59], v3 offset:53760
    s_waitcnt lgkmcnt(12)
    v_mfma_f32_32x32x16_bf16 v[32:47], v[64:67], a[80:83], v[32:47]
    ds_read_b64_tr_b16 v[60:61], v3 offset:55296
    ds_read_b64_tr_b16 v[62:63], v3 offset:55808
    s_waitcnt lgkmcnt(12)
    v_mfma_f32_32x32x16_bf16 v[32:47], v[68:71], a[84:87], v[32:47]
    v_mul_f32 v16, s77, v16
    v_mul_f32 v17, s77, v17
    v_mul_f32 v18, s77, v18
    v_mul_f32 v19, s77, v19
    ds_read_b64_tr_b16 v[64:65], v3 offset:57344
    ds_read_b64_tr_b16 v[66:67], v3 offset:57856
    s_waitcnt lgkmcnt(12)
    v_mfma_f32_32x32x16_bf16 v[32:47], v[72:75], a[88:91], v[32:47]
    v_mul_f32 v20, s77, v20
    v_mul_f32 v21, s77, v21
    v_mul_f32 v22, s77, v22
    v_mul_f32 v23, s77, v23
    ds_read_b64_tr_b16 v[68:69], v3 offset:59392
    ds_read_b64_tr_b16 v[70:71], v3 offset:59904
    s_waitcnt lgkmcnt(12)
    v_mfma_f32_32x32x16_bf16 v[32:47], v[76:79], a[92:95], v[32:47]
    v_cvt_pk_bf16_f32 v80, v16, v17
    v_cvt_pk_bf16_f32 v81, v18, v19
    v_cvt_pk_bf16_f32 v82, v20, v21
    v_cvt_pk_bf16_f32 v83, v22, v23
    ds_read_b64_tr_b16 v[72:73], v3 offset:61440
    ds_read_b64_tr_b16 v[74:75], v3 offset:61952
    s_waitcnt lgkmcnt(12)
    v_mfma_f32_32x32x16_bf16 v[32:47], v[48:51], a[96:99], v[32:47]
    buffer_store_dwordx4 v[80:83], v5, s[16:19], s50 offen sc0 sc1
    v_mul_f32 v24, s77, v24
    v_mul_f32 v25, s77, v25
    v_mul_f32 v26, s77, v26
    ds_read_b64_tr_b16 v[76:77], v3 offset:63488
    ds_read_b64_tr_b16 v[78:79], v3 offset:64000
    s_waitcnt lgkmcnt(12)
    v_mfma_f32_32x32x16_bf16 v[32:47], v[52:55], a[100:103], v[32:47]
    v_mul_f32 v27, s77, v27
    v_mul_f32 v28, s77, v28
    v_mul_f32 v29, s77, v29
    v_mul_f32 v30, s77, v30
    ds_read_b64_tr_b16 v[48:49], v100 offset:0
    ds_read_b64_tr_b16 v[50:51], v100 offset:512
    s_waitcnt lgkmcnt(12)
    v_mfma_f32_32x32x16_bf16 v[32:47], v[56:59], a[104:107], v[32:47]
    v_mul_f32 v31, s77, v31
    v_cvt_pk_bf16_f32 v84, v24, v25
    v_cvt_pk_bf16_f32 v85, v26, v27
    v_cvt_pk_bf16_f32 v86, v28, v29
    ds_read_b64_tr_b16 v[52:53], v100 offset:2048
    ds_read_b64_tr_b16 v[54:55], v100 offset:2560
    s_waitcnt lgkmcnt(12)
    v_mfma_f32_32x32x16_bf16 v[32:47], v[60:63], a[108:111], v[32:47]
    v_cvt_pk_bf16_f32 v87, v30, v31
    buffer_store_dwordx4 v[84:87], v103, s[16:19], s50 offen sc0 sc1
    ds_read_b64_tr_b16 v[56:57], v100 offset:4096
    ds_read_b64_tr_b16 v[58:59], v100 offset:4608
    s_waitcnt lgkmcnt(12)
    v_mfma_f32_32x32x16_bf16 v[32:47], v[64:67], a[112:115], v[32:47]
    ds_read_b64_tr_b16 v[60:61], v100 offset:6144
    ds_read_b64_tr_b16 v[62:63], v100 offset:6656
    s_waitcnt lgkmcnt(12)
    v_mfma_f32_32x32x16_bf16 v[32:47], v[68:71], a[116:119], v[32:47]
    s_lshr_b32 s28, s53, 1
    s_mul_i32 s27, s28, s68
    s_add_u32 s27, s27, s67
    s_cmp_ge_u32 s28, s64
    s_cselect_b32 s27, s69, s27
    s_cmp_ge_u32 s27, 128
    s_cselect_b32 s12, s20, s12
    s_cselect_b32 s13, s21, s13
    s_and_b32 s27, s27, 127
    s_lshl_b32 s54, s27, 6
    s_and_b32 s27, s53, 1
    s_lshl_b32 s27, s27, 21
    s_add_u32 s54, s54, s27
    s_and_b32 s27, s53, 3
    s_lshl_b32 s27, s27, 15
    s_add_u32 s55, s27, s34
    s_add_u32 s53, s53, 1
    ds_read_b64_tr_b16 v[64:65], v100 offset:8192
    ds_read_b64_tr_b16 v[66:67], v100 offset:8704
    s_waitcnt lgkmcnt(12)
    v_mfma_f32_32x32x16_bf16 v[32:47], v[72:75], a[120:123], v[32:47]
    ds_read_b64_tr_b16 v[68:69], v100 offset:10240
    ds_read_b64_tr_b16 v[70:71], v100 offset:10752
    s_waitcnt lgkmcnt(12)
    v_mfma_f32_32x32x16_bf16 v[32:47], v[76:79], a[124:127], v[32:47]
    v_mov_b32 v8, v103
    s_mov_b32 s33, s51
    s_branch qkv_kernel_next
qkv_kernel_bodyH:
    s_waitcnt vmcnt(8)
    s_barrier
    ds_read_b64_tr_b16 v[72:73], v2 offset:12288
    ds_read_b64_tr_b16 v[74:75], v2 offset:12800
    s_waitcnt lgkmcnt(12)
    v_mfma_f32_32x32x16_bf16 v[16:31], v[48:51], a[0:3], 0
    ds_read_b64_tr_b16 v[76:77], v2 offset:14336
    ds_read_b64_tr_b16 v[78:79], v2 offset:14848
    s_waitcnt lgkmcnt(12)
    v_mfma_f32_32x32x16_bf16 v[16:31], v[52:55], a[4:7], v[16:31]
    s_add_u32 m0, s55, 0
    s_add_u32 s35, s54, 0
    buffer_load_dwordx4 v4, s[12:15], s35 offen lds
    ds_read_b64_tr_b16 v[48:49], v2 offset:16384
    ds_read_b64_tr_b16 v[50:51], v2 offset:16896
    s_waitcnt lgkmcnt(12)
    v_mfma_f32_32x32x16_bf16 v[16:31], v[56:59], a[8:11], v[16:31]
    ds_read_b64_tr_b16 v[52:53], v2 offset:18432
    ds_read_b64_tr_b16 v[54:55], v2 offset:18944
    s_waitcnt lgkmcnt(12)
    v_mfma_f32_32x32x16_bf16 v[16:31], v[60:63], a[12:15], v[16:31]
    s_add_u32 m0, s55, 1024
    s_add_u32 s35, s54, 65536
    buffer_load_dwordx4 v4, s[12:15], s35 offen lds
    ds_read_b64_tr_b16 v[56:57], v2 offset:20480
    ds_read_b64_tr_b16 v[58:59], v2 offset:20992
    s_waitcnt lgkmcnt(12)
    v_mfma_f32_32x32x16_bf16 v[16:31], v[64:67], a[16:19], v[16:31]
    ds_read_b64_tr_b16 v[60:61], v2 offset:22528
    ds_read_b64_tr_b16 v[62:63], v2 offset:23040
    s_waitcnt lgkmcnt(12)
    v_mfma_f32_32x32x16_bf16 v[16:31], v[68:71], a[20:23], v[16:31]
    s_add_u32 m0, s55, 2048
    s_add_u32 s35, s54, 131072
    buffer_load_dwordx4 v4, s[12:15], s35 offen lds
    ds_read_b64_tr_b16 v[64:65], v2 offset:24576
    ds_read_b64_tr_b16 v[66:67], v2 offset:25088
    s_waitcnt lgkmcnt(12)
    v_mfma_f32_32x32x16_bf16 v[16:31], v[72:75], a[24:27], v[16:31]
    ds_read_b64_tr_b16 v[68:69], v2 offset:26624
    ds_read_b64_tr_b16 v[70:71], v2 offset:27136
    s_waitcnt lgkmcnt(12)
    v_mfma_f32_32x32x16_bf16 v[16:31], v[76:79], a[28:31], v[16:31]
    s_add_u32 m0, s55, 3072
    s_add_u32 s35, s54, 196608
    buffer_load_dwordx4 v4, s[12:15], s35 offen lds
    ds_read_b64_tr_b16 v[72:73], v2 offset:28672
    ds_read_b64_tr_b16 v[74:75], v2 offset:29184
    s_waitcnt lgkmcnt(12)
    v_mfma_f32_32x32x16_bf16 v[16:31], v[48:51], a[32:35], v[16:31]
    v_mul_f32 v32, s77, v32
    v_mul_f32 v33, s77, v33
    v_mul_f32 v34, s77, v34
    v_mul_f32 v35, s77, v35
    ds_read_b64_tr_b16 v[76:77], v2 offset:30720
    ds_read_b64_tr_b16 v[78:79], v2 offset:31232
    s_waitcnt lgkmcnt(12)
    v_mfma_f32_32x32x16_bf16 v[16:31], v[52:55], a[36:39], v[16:31]
    v_mul_f32 v36, s77, v36
    v_mul_f32 v37, s77, v37
    v_mul_f32 v38, s77, v38
    v_mul_f32 v39, s77, v39
    ds_read_b64_tr_b16 v[48:49], v2 offset:32768
    ds_read_b64_tr_b16 v[50:51], v2 offset:33280
    s_waitcnt lgkmcnt(12)
    v_mfma_f32_32x32x16_bf16 v[16:31], v[56:59], a[40:43], v[16:31]
    v_cvt_pk_bf16_f32 v88, v32, v33
    v_cvt_pk_bf16_f32 v89, v34, v35
    v_cvt_pk_bf16_f32 v90, v36, v37
    v_cvt_pk_bf16_f32 v91, v38, v39
    ds_read_b64_tr_b16 v[52:53], v2 offset:34816
    ds_read_b64_tr_b16 v[54:55], v2 offset:35328
    s_waitcnt lgkmcnt(12)
    v_mfma_f32_32x32x16_bf16 v[16:31], v[60:63], a[44:47], v[16:31]
    buffer_store_dwordx4 v[88:91], v5, s[16:19], s33 offen sc0 sc1
    v_mul_f32 v40, s77, v40
    v_mul_f32 v41, s77, v41
    v_mul_f32 v42, s77, v42
    ds_read_b64_tr_b16 v[56:57], v2 offset:36864
    ds_read_b64_tr_b16 v[58:59], v2 offset:37376
    s_waitcnt lgkmcnt(12)
    v_mfma_f32_32x32x16_bf16 v[16:31], v[64:67], a[48:51], v[16:31]
    v_mul_f32 v43, s77, v43
    v_mul_f32 v44, s77, v44
    v_mul_f32 v45, s77, v45
    v_mul_f32 v46, s77, v46
    ds_read_b64_tr_b16 v[60:61], v2 offset:38912
    ds_read_b64_tr_b16 v[62:63], v2 offset:39424
    s_waitcnt lgkmcnt(12)
    v_mfma_f32_32x32x16_bf16 v[16:31], v[68:71], a[52:55], v[16:31]
    s_and_b32 s49, s30, 127
    s_lshl_b32 s49, s49, 5
    s_lshr_b32 s28, s53, 1
    s_mul_i32 s27, s28, s68
    s_add_u32 s27, s27, s67
    s_cmp_ge_u32 s28, s64
    s_cselect_b32 s27, s69, s27
    s_cmp_ge_u32 s27, 128
    s_cselect_b32 s12, s20, s12
    s_cselect_b32 s13, s21, s13
    s_and_b32 s27, s27, 127
    s_lshl_b32 s54, s27, 6
    s_and_b32 s27, s53, 1
    s_lshl_b32 s27, s27, 21
    s_add_u32 s54, s54, s27
    s_and_b32 s27, s53, 3
    s_lshl_b32 s27, s27, 15
    s_add_u32 s55, s27, s34
    s_add_u32 s53, s53, 1
    v_mul_f32 v47, s77, v47
    v_cvt_pk_bf16_f32 v92, v40, v41
    v_cvt_pk_bf16_f32 v93, v42, v43
    v_cvt_pk_bf16_f32 v94, v44, v45
    ds_read_b64_tr_b16 v[64:65], v2 offset:40960
    ds_read_b64_tr_b16 v[66:67], v2 offset:41472
    s_waitcnt lgkmcnt(12)
    v_mfma_f32_32x32x16_bf16 v[16:31], v[72:75], a[56:59], v[16:31]
    s_add_u32 s28, s49, 0
    s_lshr_b32 s50, s28, 7
    v_cvt_pk_bf16_f32 v95, v46, v47
    buffer_store_dwordx4 v[92:95], v8, s[16:19], s33 offen sc0 sc1
    ds_read_b64_tr_b16 v[68:69], v2 offset:43008
    ds_read_b64_tr_b16 v[70:71], v2 offset:43520
    s_waitcnt lgkmcnt(12)
    v_mfma_f32_32x32x16_bf16 v[16:31], v[76:79], a[60:63], v[16:31]
    s_lshl_b32 s50, s50, 19
    s_and_b32 s28, s28, 127
    s_waitcnt vmcnt(8)
    s_barrier
    ds_read_b64_tr_b16 v[72:73], v2 offset:45056
    ds_read_b64_tr_b16 v[74:75], v2 offset:45568
    s_waitcnt lgkmcnt(12)
    v_mfma_f32_32x32x16_bf16 v[16:31], v[48:51], a[64:67], v[16:31]
    s_lshl_b32 s28, s28, 6
    s_add_u32 s50, s50, s28
    ds_read_b64_tr_b16 v[76:77], v2 offset:47104
    ds_read_b64_tr_b16 v[78:79], v2 offset:47616
    s_waitcnt lgkmcnt(12)
    v_mfma_f32_32x32x16_bf16 v[16:31], v[52:55], a[68:71], v[16:31]
    s_add_u32 m0, s55, 0
    s_add_u32 s35, s54, 0
    buffer_load_dwordx4 v4, s[12:15], s35 offen lds
    s_add_u32 s50, s50, s29
    s_add_u32 s28, s49, 32
    ds_read_b64_tr_b16 v[48:49], v2 offset:49152
    ds_read_b64_tr_b16 v[50:51], v2 offset:49664
    s_waitcnt lgkmcnt(12)
    v_mfma_f32_32x32x16_bf16 v[16:31], v[56:59], a[72:75], v[16:31]
    s_lshr_b32 s51, s28, 7
    s_lshl_b32 s51, s51, 19
    ds_read_b64_tr_b16 v[52:53], v2 offset:51200
    ds_read_b64_tr_b16 v[54:55], v2 offset:51712
    s_waitcnt lgkmcnt(12)
    v_mfma_f32_32x32x16_bf16 v[16:31], v[60:63], a[76:79], v[16:31]
    s_add_u32 m0, s55, 1024
    s_add_u32 s35, s54, 65536
    buffer_load_dwordx4 v4, s[12:15], s35 offen lds
    s_and_b32 s28, s28, 127
    s_lshl_b32 s28, s28, 6
    ds_read_b64_tr_b16 v[56:57], v2 offset:53248
    ds_read_b64_tr_b16 v[58:59], v2 offset:53760
    s_waitcnt lgkmcnt(12)
    v_mfma_f32_32x32x16_bf16 v[16:31], v[64:67], a[80:83], v[16:31]
    s_add_u32 s51, s51, s28
    s_add_u32 s51, s51, s29
    ds_read_b64_tr_b16 v[60:61], v2 offset:55296
    ds_read_b64_tr_b16 v[62:63], v2 offset:55808
    s_waitcnt lgkmcnt(12)
    v_mfma_f32_32x32x16_bf16 v[16:31], v[68:71], a[84:87], v[16:31]
    s_add_u32 m0, s55, 2048
    s_add_u32 s35, s54, 131072
    buffer_load_dwordx4 v4, s[12:15], s35 offen lds
    ds_read_b64_tr_b16 v[64:65], v2 offset:57344
    ds_read_b64_tr_b16 v[66:67], v2 offset:57856
    s_waitcnt lgkmcnt(12)
    v_mfma_f32_32x32x16_bf16 v[16:31], v[72:75], a[88:91], v[16:31]
    ds_read_b64_tr_b16 v[68:69], v2 offset:59392
    ds_read_b64_tr_b16 v[70:71], v2 offset:59904
    s_waitcnt lgkmcnt(12)
    v_mfma_f32_32x32x16_bf16 v[16:31], v[76:79], a[92:95], v[16:31]
    s_add_u32 m0, s55, 3072
    s_add_u32 s35, s54, 196608
    buffer_load_dwordx4 v4, s[12:15], s35 offen lds
    ds_read_b64_tr_b16 v[72:73], v2 offset:61440
    ds_read_b64_tr_b16 v[74:75], v2 offset:61952
    s_waitcnt lgkmcnt(12)
    v_mfma_f32_32x32x16_bf16 v[16:31], v[48:51], a[96:99], v[16:31]
    ds_read_b64_tr_b16 v[76:77], v2 offset:63488
    ds_read_b64_tr_b16 v[78:79], v2 offset:64000
    s_waitcnt lgkmcnt(12)
    v_mfma_f32_32x32x16_bf16 v[16:31], v[52:55], a[100:103], v[16:31]
    s_waitcnt lgkmcnt(10)
    v_mfma_f32_32x32x16_bf16 v[16:31], v[56:59], a[104:107], v[16:31]
    s_waitcnt lgkmcnt(8)
    v_mfma_f32_32x32x16_bf16 v[16:31], v[60:63], a[108:111], v[16:31]
    s_waitcnt lgkmcnt(6)
    v_mfma_f32_32x32x16_bf16 v[16:31], v[64:67], a[112:115], v[16:31]
    s_waitcnt lgkmcnt(4)
    v_mfma_f32_32x32x16_bf16 v[16:31], v[68:71], a[116:119], v[16:31]
    s_lshr_b32 s28, s53, 1
    s_mul_i32 s27, s28, s68
    s_add_u32 s27, s27, s67
    s_cmp_ge_u32 s28, s64
    s_cselect_b32 s27, s69, s27
    s_cmp_ge_u32 s27, 128
    s_cselect_b32 s12, s20, s12
    s_cselect_b32 s13, s21, s13
    s_and_b32 s27, s27, 127
    s_lshl_b32 s54, s27, 6
    s_and_b32 s27, s53, 1
    s_lshl_b32 s27, s27, 21
    s_add_u32 s54, s54, s27
    s_and_b32 s27, s53, 3
    s_lshl_b32 s27, s27, 15
    s_add_u32 s55, s27, s34
    s_add_u32 s53, s53, 1
    s_waitcnt lgkmcnt(2)
    v_mfma_f32_32x32x16_bf16 v[16:31], v[72:75], a[120:123], v[16:31]
    s_waitcnt lgkmcnt(0)
    v_mfma_f32_32x32x16_bf16 v[16:31], v[76:79], a[124:127], v[16:31]
    s_nop 15
    v_mul_f32 v16, s77, v16
    v_mul_f32 v17, s77, v17
    v_mul_f32 v18, s77, v18
    v_mul_f32 v19, s77, v19
    v_mul_f32 v20, s77, v20
    v_mul_f32 v21, s77, v21
    v_mul_f32 v22, s77, v22
    v_mul_f32 v23, s77, v23
    v_cvt_pk_bf16_f32 v80, v16, v17
    v_cvt_pk_bf16_f32 v81, v18, v19
    v_cvt_pk_bf16_f32 v82, v20, v21
    v_cvt_pk_bf16_f32 v83, v22, v23
    buffer_store_dwordx4 v[80:83], v5, s[16:19], s50 offen sc0 sc1
    v_mul_f32 v24, s77, v24
    v_mul_f32 v25, s77, v25
    v_mul_f32 v26, s77, v26
    v_mul_f32 v27, s77, v27
    v_mul_f32 v28, s77, v28
    v_mul_f32 v29, s77, v29
    v_mul_f32 v30, s77, v30
    v_mul_f32 v31, s77, v31
    v_cvt_pk_bf16_f32 v84, v24, v25
    v_cvt_pk_bf16_f32 v85, v26, v27
    v_cvt_pk_bf16_f32 v86, v28, v29
    v_cvt_pk_bf16_f32 v87, v30, v31
    buffer_store_dwordx4 v[84:87], v103, s[16:19], s50 offen sc0 sc1
    s_branch qkv_kernel_done
qkv_kernel_bodyV:
    s_waitcnt vmcnt(8)
    s_barrier
    ds_read_b64_tr_b16 v[72:73], v2 offset:12288
    ds_read_b64_tr_b16 v[74:75], v2 offset:12800
    s_waitcnt lgkmcnt(12)
    v_mfma_f32_32x32x16_bf16 v[16:31], a[0:3], v[48:51], 0
    ds_read_b64_tr_b16 v[76:77], v2 offset:14336
    ds_read_b64_tr_b16 v[78:79], v2 offset:14848
    s_waitcnt lgkmcnt(12)
    v_mfma_f32_32x32x16_bf16 v[16:31], a[4:7], v[52:55], v[16:31]
    s_add_u32 m0, s55, 0
    s_add_u32 s35, s54, 0
    buffer_load_dwordx4 v4, s[12:15], s35 offen lds
    ds_read_b64_tr_b16 v[48:49], v2 offset:16384
    ds_read_b64_tr_b16 v[50:51], v2 offset:16896
    s_waitcnt lgkmcnt(12)
    v_mfma_f32_32x32x16_bf16 v[16:31], a[8:11], v[56:59], v[16:31]
    ds_read_b64_tr_b16 v[52:53], v2 offset:18432
    ds_read_b64_tr_b16 v[54:55], v2 offset:18944
    s_waitcnt lgkmcnt(12)
    v_mfma_f32_32x32x16_bf16 v[16:31], a[12:15], v[60:63], v[16:31]
    s_add_u32 m0, s55, 1024
    s_add_u32 s35, s54, 65536
    buffer_load_dwordx4 v4, s[12:15], s35 offen lds
    ds_read_b64_tr_b16 v[56:57], v2 offset:20480
    ds_read_b64_tr_b16 v[58:59], v2 offset:20992
    s_waitcnt lgkmcnt(12)
    v_mfma_f32_32x32x16_bf16 v[16:31], a[16:19], v[64:67], v[16:31]
    ds_read_b64_tr_b16 v[60:61], v2 offset:22528
    ds_read_b64_tr_b16 v[62:63], v2 offset:23040
    s_waitcnt lgkmcnt(12)
    v_mfma_f32_32x32x16_bf16 v[16:31], a[20:23], v[68:71], v[16:31]
    s_add_u32 m0, s55, 2048
    s_add_u32 s35, s54, 131072
    buffer_load_dwordx4 v4, s[12:15], s35 offen lds
    ds_read_b64_tr_b16 v[64:65], v2 offset:24576
    ds_read_b64_tr_b16 v[66:67], v2 offset:25088
    s_waitcnt lgkmcnt(12)
    v_mfma_f32_32x32x16_bf16 v[16:31], a[24:27], v[72:75], v[16:31]
    ds_read_b64_tr_b16 v[68:69], v2 offset:26624
    ds_read_b64_tr_b16 v[70:71], v2 offset:27136
    s_waitcnt lgkmcnt(12)
    v_mfma_f32_32x32x16_bf16 v[16:31], a[28:31], v[76:79], v[16:31]
    s_add_u32 m0, s55, 3072
    s_add_u32 s35, s54, 196608
    buffer_load_dwordx4 v4, s[12:15], s35 offen lds
    ds_read_b64_tr_b16 v[72:73], v2 offset:28672
    ds_read_b64_tr_b16 v[74:75], v2 offset:29184
    s_waitcnt lgkmcnt(12)
    v_mfma_f32_32x32x16_bf16 v[16:31], a[32:35], v[48:51], v[16:31]
    v_mul_f32 v32, s77, v32
    v_mul_f32 v33, s77, v33
    v_mul_f32 v34, s77, v34
    v_mul_f32 v35, s77, v35
    ds_read_b64_tr_b16 v[76:77], v2 offset:30720
    ds_read_b64_tr_b16 v[78:79], v2 offset:31232
    s_waitcnt lgkmcnt(12)
    v_mfma_f32_32x32x16_bf16 v[16:31], a[36:39], v[52:55], v[16:31]
    v_mul_f32 v36, s77, v36
    v_mul_f32 v37, s77, v37
    v_mul_f32 v38, s77, v38
    v_mul_f32 v39, s77, v39
    ds_read_b64_tr_b16 v[48:49], v3 offset:0
    ds_read_b64_tr_b16 v[50:51], v3 offset:512
    s_waitcnt lgkmcnt(12)
    v_mfma_f32_32x32x16_bf16 v[16:31], a[40:43], v[56:59], v[16:31]
    v_cvt_pk_bf16_f32 v88, v32, v33
    v_cvt_pk_bf16_f32 v89, v34, v35
    v_cvt_pk_bf16_f32 v90, v36, v37
    v_cvt_pk_bf16_f32 v91, v38, v39
    ds_read_b64_tr_b16 v[52:53], v3 offset:2048
    ds_read_b64_tr_b16 v[54:55], v3 offset:2560
    s_waitcnt lgkmcnt(12)
    v_mfma_f32_32x32x16_bf16 v[16:31], a[44:47], v[60:63], v[16:31]
    buffer_store_dwordx4 v[88:91], v5, s[16:19], s33 offen sc0 sc1
    v_mul_f32 v40, s77, v40
    v_mul_f32 v41, s77, v41
    v_mul_f32 v42, s77, v42
    ds_read_b64_tr_b16 v[56:57], v3 offset:4096
    ds_read_b64_tr_b16 v[58:59], v3 offset:4608
    s_waitcnt lgkmcnt(12)
    v_mfma_f32_32x32x16_bf16 v[16:31], a[48:51], v[64:67], v[16:31]
    v_mul_f32 v43, s77, v43
    v_mul_f32 v44, s77, v44
    v_mul_f32 v45, s77, v45
    v_mul_f32 v46, s77, v46
    ds_read_b64_tr_b16 v[60:61], v3 offset:6144
    ds_read_b64_tr_b16 v[62:63], v3 offset:6656
    s_waitcnt lgkmcnt(12)
    v_mfma_f32_32x32x16_bf16 v[16:31], a[52:55], v[68:71], v[16:31]
    v_mul_f32 v47, s77, v47
    v_cvt_pk_bf16_f32 v92, v40, v41
    v_cvt_pk_bf16_f32 v93, v42, v43
    v_cvt_pk_bf16_f32 v94, v44, v45
    ds_read_b64_tr_b16 v[64:65], v3 offset:8192
    ds_read_b64_tr_b16 v[66:67], v3 offset:8704
    s_waitcnt lgkmcnt(12)
    v_mfma_f32_32x32x16_bf16 v[16:31], a[56:59], v[72:75], v[16:31]
    s_and_b32 s49, s30, 127
    s_lshl_b32 s49, s49, 5
    v_cvt_pk_bf16_f32 v95, v46, v47
    buffer_store_dwordx4 v[92:95], v8, s[16:19], s33 offen sc0 sc1
    ds_read_b64_tr_b16 v[68:69], v3 offset:10240
    ds_read_b64_tr_b16 v[70:71], v3 offset:10752
    s_waitcnt lgkmcnt(12)
    v_mfma_f32_32x32x16_bf16 v[16:31], a[60:63], v[76:79], v[16:31]
    s_add_u32 s28, s49, 0
    s_lshr_b32 s50, s28, 7
    ds_read_b64_tr_b16 v[72:73], v3 offset:12288
    ds_read_b64_tr_b16 v[74:75], v3 offset:12800
    s_waitcnt lgkmcnt(12)
    v_mfma_f32_32x32x16_bf16 v[32:47], a[0:3], v[48:51], 0
    s_lshl_b32 s50, s50, 19
    s_and_b32 s28, s28, 127
    ds_read_b64_tr_b16 v[76:77], v3 offset:14336
    ds_read_b64_tr_b16 v[78:79], v3 offset:14848
    s_waitcnt lgkmcnt(12)
    v_mfma_f32_32x32x16_bf16 v[32:47], a[4:7], v[52:55], v[32:47]
    s_lshl_b32 s28, s28, 5
    s_add_u32 s50, s50, s28
    ds_read_b64_tr_b16 v[48:49], v3 offset:16384
    ds_read_b64_tr_b16 v[50:51], v3 offset:16896
    s_waitcnt lgkmcnt(12)
    v_mfma_f32_32x32x16_bf16 v[32:47], a[8:11], v[56:59], v[32:47]
    s_add_u32 s50, s50, 33554432
    s_add_u32 s28, s49, 32
    ds_read_b64_tr_b16 v[52:53], v3 offset:18432
    ds_read_b64_tr_b16 v[54:55], v3 offset:18944
    s_waitcnt lgkmcnt(12)
    v_mfma_f32_32x32x16_bf16 v[32:47], a[12:15], v[60:63], v[32:47]
    s_lshr_b32 s51, s28, 7
    s_lshl_b32 s51, s51, 19
    ds_read_b64_tr_b16 v[56:57], v3 offset:20480
    ds_read_b64_tr_b16 v[58:59], v3 offset:20992
    s_waitcnt lgkmcnt(12)
    v_mfma_f32_32x32x16_bf16 v[32:47], a[16:19], v[64:67], v[32:47]
    s_and_b32 s28, s28, 127
    s_lshl_b32 s28, s28, 5
    ds_read_b64_tr_b16 v[60:61], v3 offset:22528
    ds_read_b64_tr_b16 v[62:63], v3 offset:23040
    s_waitcnt lgkmcnt(12)
    v_mfma_f32_32x32x16_bf16 v[32:47], a[20:23], v[68:71], v[32:47]
    s_add_u32 s51, s51, s28
    s_add_u32 s51, s51, 33554432
    ds_read_b64_tr_b16 v[64:65], v3 offset:24576
    ds_read_b64_tr_b16 v[66:67], v3 offset:25088
    s_waitcnt lgkmcnt(12)
    v_mfma_f32_32x32x16_bf16 v[32:47], a[24:27], v[72:75], v[32:47]
    ds_read_b64_tr_b16 v[68:69], v3 offset:26624
    ds_read_b64_tr_b16 v[70:71], v3 offset:27136
    s_waitcnt lgkmcnt(12)
    v_mfma_f32_32x32x16_bf16 v[32:47], a[28:31], v[76:79], v[32:47]
    ds_read_b64_tr_b16 v[72:73], v3 offset:28672
    ds_read_b64_tr_b16 v[74:75], v3 offset:29184
    s_waitcnt lgkmcnt(12)
    v_mfma_f32_32x32x16_bf16 v[32:47], a[32:35], v[48:51], v[32:47]
    ds_read_b64_tr_b16 v[76:77], v3 offset:30720
    ds_read_b64_tr_b16 v[78:79], v3 offset:31232
    s_waitcnt lgkmcnt(12)
    v_mfma_f32_32x32x16_bf16 v[32:47], a[36:39], v[52:55], v[32:47]
    ds_read_b64_tr_b16 v[48:49], v2 offset:32768
    ds_read_b64_tr_b16 v[50:51], v2 offset:33280
    s_waitcnt lgkmcnt(12)
    v_mfma_f32_32x32x16_bf16 v[32:47], a[40:43], v[56:59], v[32:47]
    ds_read_b64_tr_b16 v[52:53], v2 offset:34816
    ds_read_b64_tr_b16 v[54:55], v2 offset:35328
    s_waitcnt lgkmcnt(12)
    v_mfma_f32_32x32x16_bf16 v[32:47], a[44:47], v[60:63], v[32:47]
    ds_read_b64_tr_b16 v[56:57], v2 offset:36864
    ds_read_b64_tr_b16 v[58:59], v2 offset:37376
    s_waitcnt lgkmcnt(12)
    v_mfma_f32_32x32x16_bf16 v[32:47], a[48:51], v[64:67], v[32:47]
    ds_read_b64_tr_b16 v[60:61], v2 offset:38912
    ds_read_b64_tr_b16 v[62:63], v2 offset:39424
    s_waitcnt lgkmcnt(12)
    v_mfma_f32_32x32x16_bf16 v[32:47], a[52:55], v[68:71], v[32:47]
    s_lshr_b32 s28, s53, 1
    s_mul_i32 s27, s28, s68
    s_add_u32 s27, s27, s67
    s_cmp_ge_u32 s28, s64
    s_cselect_b32 s27, s69, s27
    s_cmp_ge_u32 s27, 128
    s_cselect_b32 s12, s20, s12
    s_cselect_b32 s13, s21, s13
    s_and_b32 s27, s27, 127
    s_lshl_b32 s54, s27, 6
    s_and_b32 s27, s53, 1
    s_lshl_b32 s27, s27, 21
    s_add_u32 s54, s54, s27
    s_and_b32 s27, s53, 3
    s_lshl_b32 s27, s27, 15
    s_add_u32 s55, s27, s34
    s_add_u32 s53, s53, 1
    ds_read_b64_tr_b16 v[64:65], v2 offset:40960
    ds_read_b64_tr_b16 v[66:67], v2 offset:41472
    s_waitcnt lgkmcnt(12)
    v_mfma_f32_32x32x16_bf16 v[32:47], a[56:59], v[72:75], v[32:47]
    ds_read_b64_tr_b16 v[68:69], v2 offset:43008
    ds_read_b64_tr_b16 v[70:71], v2 offset:43520
    s_waitcnt lgkmcnt(12)
    v_mfma_f32_32x32x16_bf16 v[32:47], a[60:63], v[76:79], v[32:47]
    s_waitcnt vmcnt(8)
    s_barrier
    ds_read_b64_tr_b16 v[72:73], v2 offset:45056
    ds_read_b64_tr_b16 v[74:75], v2 offset:45568
    s_waitcnt lgkmcnt(12)
    v_mfma_f32_32x32x16_bf16 v[16:31], a[64:67], v[48:51], v[16:31]
    ds_read_b64_tr_b16 v[76:77], v2 offset:47104
    ds_read_b64_tr_b16 v[78:79], v2 offset:47616
    s_waitcnt lgkmcnt(12)
    v_mfma_f32_32x32x16_bf16 v[16:31], a[68:71], v[52:55], v[16:31]
    s_add_u32 m0, s55, 0
    s_add_u32 s35, s54, 0
    buffer_load_dwordx4 v4, s[12:15], s35 offen lds
    ds_read_b64_tr_b16 v[48:49], v2 offset:49152
    ds_read_b64_tr_b16 v[50:51], v2 offset:49664
    s_waitcnt lgkmcnt(12)
    v_mfma_f32_32x32x16_bf16 v[16:31], a[72:75], v[56:59], v[16:31]
    ds_read_b64_tr_b16 v[52:53], v2 offset:51200
    ds_read_b64_tr_b16 v[54:55], v2 offset:51712
    s_waitcnt lgkmcnt(12)
    v_mfma_f32_32x32x16_bf16 v[16:31], a[76:79], v[60:63], v[16:31]
    s_add_u32 m0, s55, 1024
    s_add_u32 s35, s54, 65536
    buffer_load_dwordx4 v4, s[12:15], s35 offen lds
    ds_read_b64_tr_b16 v[56:57], v2 offset:53248
    ds_read_b64_tr_b16 v[58:59], v2 offset:53760
    s_waitcnt lgkmcnt(12)
    v_mfma_f32_32x32x16_bf16 v[16:31], a[80:83], v[64:67], v[16:31]
    ds_read_b64_tr_b16 v[60:61], v2 offset:55296
    ds_read_b64_tr_b16 v[62:63], v2 offset:55808
    s_waitcnt lgkmcnt(12)
    v_mfma_f32_32x32x16_bf16 v[16:31], a[84:87], v[68:71], v[16:31]
    s_add_u32 m0, s55, 2048
    s_add_u32 s35, s54, 131072
    buffer_load_dwordx4 v4, s[12:15], s35 offen lds
    ds_read_b64_tr_b16 v[64:65], v2 offset:57344
    ds_read_b64_tr_b16 v[66:67], v2 offset:57856
    s_waitcnt lgkmcnt(12)
    v_mfma_f32_32x32x16_bf16 v[16:31], a[88:91], v[72:75], v[16:31]
    ds_read_b64_tr_b16 v[68:69], v2 offset:59392
    ds_read_b64_tr_b16 v[70:71], v2 offset:59904
    s_waitcnt lgkmcnt(12)
    v_mfma_f32_32x32x16_bf16 v[16:31], a[92:95], v[76:79], v[16:31]
    s_add_u32 m0, s55, 3072
    s_add_u32 s35, s54, 196608
    buffer_load_dwordx4 v4, s[12:15], s35 offen lds
    ds_read_b64_tr_b16 v[72:73], v2 offset:61440
    ds_read_b64_tr_b16 v[74:75], v2 offset:61952
    s_waitcnt lgkmcnt(12)
    v_mfma_f32_32x32x16_bf16 v[16:31], a[96:99], v[48:51], v[16:31]
    ds_read_b64_tr_b16 v[76:77], v2 offset:63488
    ds_read_b64_tr_b16 v[78:79], v2 offset:64000
    s_waitcnt lgkmcnt(12)
    v_mfma_f32_32x32x16_bf16 v[16:31], a[100:103], v[52:55], v[16:31]
    ds_read_b64_tr_b16 v[48:49], v3 offset:32768
    ds_read_b64_tr_b16 v[50:51], v3 offset:33280
    s_waitcnt lgkmcnt(12)
    v_mfma_f32_32x32x16_bf16 v[16:31], a[104:107], v[56:59], v[16:31]
    ds_read_b64_tr_b16 v[52:53], v3 offset:34816
    ds_read_b64_tr_b16 v[54:55], v3 offset:35328
    s_waitcnt lgkmcnt(12)
    v_mfma_f32_32x32x16_bf16 v[16:31], a[108:111], v[60:63], v[16:31]
    ds_read_b64_tr_b16 v[56:57], v3 offset:36864
    ds_read_b64_tr_b16 v[58:59], v3 offset:37376
    s_waitcnt lgkmcnt(12)
    v_mfma_f32_32x32x16_bf16 v[16:31], a[112:115], v[64:67], v[16:31]
    ds_read_b64_tr_b16 v[60:61], v3 offset:38912
    ds_read_b64_tr_b16 v[62:63], v3 offset:39424
    s_waitcnt lgkmcnt(12)
    v_mfma_f32_32x32x16_bf16 v[16:31], a[116:119], v[68:71], v[16:31]
    ds_read_b64_tr_b16 v[64:65], v3 offset:40960
    ds_read_b64_tr_b16 v[66:67], v3 offset:41472
    s_waitcnt lgkmcnt(12)
    v_mfma_f32_32x32x16_bf16 v[16:31], a[120:123], v[72:75], v[16:31]
    ds_read_b64_tr_b16 v[68:69], v3 offset:43008
    ds_read_b64_tr_b16 v[70:71], v3 offset:43520
    s_waitcnt lgkmcnt(12)
    v_mfma_f32_32x32x16_bf16 v[16:31], a[124:127], v[76:79], v[16:31]
    ds_read_b64_tr_b16 v[72:73], v3 offset:45056
    ds_read_b64_tr_b16 v[74:75], v3 offset:45568
    s_waitcnt lgkmcnt(12)
    v_mfma_f32_32x32x16_bf16 v[32:47], a[64:67], v[48:51], v[32:47]
    ds_read_b64_tr_b16 v[76:77], v3 offset:47104
    ds_read_b64_tr_b16 v[78:79], v3 offset:47616
    s_waitcnt lgkmcnt(12)
    v_mfma_f32_32x32x16_bf16 v[32:47], a[68:71], v[52:55], v[32:47]
    ds_read_b64_tr_b16 v[48:49], v3 offset:49152
    ds_read_b64_tr_b16 v[50:51], v3 offset:49664
    s_waitcnt lgkmcnt(12)
    v_mfma_f32_32x32x16_bf16 v[32:47], a[72:75], v[56:59], v[32:47]
    ds_read_b64_tr_b16 v[52:53], v3 offset:51200
    ds_read_b64_tr_b16 v[54:55], v3 offset:51712
    s_waitcnt lgkmcnt(12)
    v_mfma_f32_32x32x16_bf16 v[32:47], a[76:79], v[60:63], v[32:47]
    ds_read_b64_tr_b16 v[56:57], v3 offset:53248
    ds_read_b64_tr_b16 v[58:59], v3 offset:53760
    s_waitcnt lgkmcnt(12)
    v_mfma_f32_32x32x16_bf16 v[32:47], a[80:83], v[64:67], v[32:47]
    ds_read_b64_tr_b16 v[60:61], v3 offset:55296
    ds_read_b64_tr_b16 v[62:63], v3 offset:55808
    s_waitcnt lgkmcnt(12)
    v_mfma_f32_32x32x16_bf16 v[32:47], a[84:87], v[68:71], v[32:47]
    v_mul_f32 v16, s77, v16
    v_mul_f32 v17, s77, v17
    v_mul_f32 v18, s77, v18
    v_mul_f32 v19, s77, v19
    ds_read_b64_tr_b16 v[64:65], v3 offset:57344
    ds_read_b64_tr_b16 v[66:67], v3 offset:57856
    s_waitcnt lgkmcnt(12)
    v_mfma_f32_32x32x16_bf16 v[32:47], a[88:91], v[72:75], v[32:47]
    v_mul_f32 v20, s77, v20
    v_mul_f32 v21, s77, v21
    v_mul_f32 v22, s77, v22
    v_mul_f32 v23, s77, v23
    ds_read_b64_tr_b16 v[68:69], v3 offset:59392
    ds_read_b64_tr_b16 v[70:71], v3 offset:59904
    s_waitcnt lgkmcnt(12)
    v_mfma_f32_32x32x16_bf16 v[32:47], a[92:95], v[76:79], v[32:47]
    v_cvt_pk_bf16_f32 v80, v16, v17
    v_cvt_pk_bf16_f32 v81, v18, v19
    v_cvt_pk_bf16_f32 v82, v20, v21
    v_cvt_pk_bf16_f32 v83, v22, v23
    ds_read_b64_tr_b16 v[72:73], v3 offset:61440
    ds_read_b64_tr_b16 v[74:75], v3 offset:61952
    s_waitcnt lgkmcnt(12)
    v_mfma_f32_32x32x16_bf16 v[32:47], a[96:99], v[48:51], v[32:47]
    buffer_store_dwordx4 v[80:83], v5, s[16:19], s50 offen sc0 sc1
    v_mul_f32 v24, s77, v24
    v_mul_f32 v25, s77, v25
    v_mul_f32 v26, s77, v26
    ds_read_b64_tr_b16 v[76:77], v3 offset:63488
    ds_read_b64_tr_b16 v[78:79], v3 offset:64000
    s_waitcnt lgkmcnt(12)
    v_mfma_f32_32x32x16_bf16 v[32:47], a[100:103], v[52:55], v[32:47]
    v_mul_f32 v27, s77, v27
    v_mul_f32 v28, s77, v28
    v_mul_f32 v29, s77, v29
    v_mul_f32 v30, s77, v30
    ds_read_b64_tr_b16 v[48:49], v100 offset:0
    ds_read_b64_tr_b16 v[50:51], v100 offset:512
    s_waitcnt lgkmcnt(12)
    v_mfma_f32_32x32x16_bf16 v[32:47], a[104:107], v[56:59], v[32:47]
    v_mul_f32 v31, s77, v31
    v_cvt_pk_bf16_f32 v84, v24, v25
    v_cvt_pk_bf16_f32 v85, v26, v27
    v_cvt_pk_bf16_f32 v86, v28, v29
    ds_read_b64_tr_b16 v[52:53], v100 offset:2048
    ds_read_b64_tr_b16 v[54:55], v100 offset:2560
    s_waitcnt lgkmcnt(12)
    v_mfma_f32_32x32x16_bf16 v[32:47], a[108:111], v[60:63], v[32:47]
    v_cvt_pk_bf16_f32 v87, v30, v31
    buffer_store_dwordx4 v[84:87], v6, s[16:19], s50 offen sc0 sc1
    ds_read_b64_tr_b16 v[56:57], v100 offset:4096
    ds_read_b64_tr_b16 v[58:59], v100 offset:4608
    s_waitcnt lgkmcnt(12)
    v_mfma_f32_32x32x16_bf16 v[32:47], a[112:115], v[64:67], v[32:47]
    ds_read_b64_tr_b16 v[60:61], v100 offset:6144
    ds_read_b64_tr_b16 v[62:63], v100 offset:6656
    s_waitcnt lgkmcnt(12)
    v_mfma_f32_32x32x16_bf16 v[32:47], a[116:119], v[68:71], v[32:47]
    s_lshr_b32 s28, s53, 1
    s_mul_i32 s27, s28, s68
    s_add_u32 s27, s27, s67
    s_cmp_ge_u32 s28, s64
    s_cselect_b32 s27, s69, s27
    s_cmp_ge_u32 s27, 128
    s_cselect_b32 s12, s20, s12
    s_cselect_b32 s13, s21, s13
    s_and_b32 s27, s27, 127
    s_lshl_b32 s54, s27, 6
    s_and_b32 s27, s53, 1
    s_lshl_b32 s27, s27, 21
    s_add_u32 s54, s54, s27
    s_and_b32 s27, s53, 3
    s_lshl_b32 s27, s27, 15
    s_add_u32 s55, s27, s34
    s_add_u32 s53, s53, 1
    ds_read_b64_tr_b16 v[64:65], v100 offset:8192
    ds_read_b64_tr_b16 v[66:67], v100 offset:8704
    s_waitcnt lgkmcnt(12)
    v_mfma_f32_32x32x16_bf16 v[32:47], a[120:123], v[72:75], v[32:47]
    ds_read_b64_tr_b16 v[68:69], v100 offset:10240
    ds_read_b64_tr_b16 v[70:71], v100 offset:10752
    s_waitcnt lgkmcnt(12)
    v_mfma_f32_32x32x16_bf16 v[32:47], a[124:127], v[76:79], v[32:47]
    v_mov_b32 v8, v6
    s_mov_b32 s33, s51
    s_branch qkv_kernel_next
qkv_kernel_next:
    v_mov_b32 v2, v100
    v_mov_b32 v3, v101
    s_add_u32 s66, s66, 1
    s_add_u32 s30, s30, s68
    s_cmp_ge_u32 s66, s64
    s_cselect_b32 s30, s69, s30
    s_cmp_lt_u32 s66, s65
    s_cbranch_scc1 qkv_kernel_loop
    s_nop 15
    v_mul_f32 v32, s77, v32
    v_mul_f32 v33, s77, v33
    v_mul_f32 v34, s77, v34
    v_mul_f32 v35, s77, v35
    v_mul_f32 v36, s77, v36
    v_mul_f32 v37, s77, v37
    v_mul_f32 v38, s77, v38
    v_mul_f32 v39, s77, v39
    v_cvt_pk_bf16_f32 v88, v32, v33
    v_cvt_pk_bf16_f32 v89, v34, v35
    v_cvt_pk_bf16_f32 v90, v36, v37
    v_cvt_pk_bf16_f32 v91, v38, v39
    buffer_store_dwordx4 v[88:91], v5, s[16:19], s33 offen sc0 sc1
    v_mul_f32 v40, s77, v40
    v_mul_f32 v41, s77, v41
    v_mul_f32 v42, s77, v42
    v_mul_f32 v43, s77, v43
    v_mul_f32 v44, s77, v44
    v_mul_f32 v45, s77, v45
    v_mul_f32 v46, s77, v46
    v_mul_f32 v47, s77, v47
    v_cvt_pk_bf16_f32 v92, v40, v41
    v_cvt_pk_bf16_f32 v93, v42, v43
    v_cvt_pk_bf16_f32 v94, v44, v45
    v_cvt_pk_bf16_f32 v95, v46, v47
    buffer_store_dwordx4 v[92:95], v8, s[16:19], s33 offen sc0 sc1
qkv_kernel_done:
    s_endpgm
.globl attn_kernel
.p2align 8
.type attn_kernel,@function
attn_kernel:
    s_cmp_ge_u32 s2, 256
    s_cbranch_scc1 attn_kernel_done
    s_load_dwordx2 s[46:47], s[0:1], 136
    s_load_dwordx2 s[48:49], s[0:1], 40
    v_and_b32 v1, 63, v0
    v_lshrrev_b32 v14, 6, v0
    s_nop 0
    v_readfirstlane_b32 s24, v14
    s_lshr_b32 s25, s24, 2
    s_and_b32 s26, s24, 3
    s_and_b32 s27, s2, 7
    s_lshl_b32 s27, s27, 2
    s_lshr_b32 s28, s2, 3
    s_and_b32 s28, s28, 3
    s_add_u32 s27, s27, s28
    s_lshr_b32 s28, s2, 5
    s_lshl_b32 s29, s27, 19
    s_lshl_b32 s30, s25, 16
    v_lshlrev_b32 v12, 4, v1
    v_add_u32 v13, s30, v12
    s_lshl_b32 s32, s25, 14
    s_lshl_b32 s33, s26, 12
    s_add_u32 s32, s32, s33
    s_add_u32 s32, s32, s29
    s_add_u32 s33, s32, 33554432
    s_add_u32 s32, s32, 16777216
    s_lshl_b32 s34, s26, 12
    s_add_u32 s34, s34, s30
    s_add_u32 s35, s34, 32768
    s_sub_u32 s37, 15, s28
    s_add_u32 s58, s37, 1
    s_waitcnt lgkmcnt(0)
    s_mov_b32 s16, s46
    s_and_b32 s17, s47, 0xffff
    s_mov_b32 s18, 268435456
    s_mov_b32 s19, 0x00020000
    s_add_u32 m0, s34, 0
    s_nop 0
    buffer_load_dwordx4 v12, s[16:19], s32 offen lds
    buffer_load_dwordx4 v12, s[16:19], s32 offen offset:1024 lds
    buffer_load_dwordx4 v12, s[16:19], s32 offen offset:2048 lds
    buffer_load_dwordx4 v12, s[16:19], s32 offen offset:3072 lds
    s_lshl_b32 s39, s37, 15
    s_lshl_b32 s44, s24, 12
    s_add_u32 s39, s39, s44
    s_add_u32 s39, s39, s29
    s_add_u32 s39, s39, 0
    s_add_u32 m0, s44, 131072
    s_nop 0
    buffer_load_dwordx4 v12, s[16:19], s39 offen offset:0 lds
    buffer_load_dwordx4 v12, s[16:19], s39 offen offset:1024 lds
    buffer_load_dwordx4 v12, s[16:19], s39 offen offset:2048 lds
    buffer_load_dwordx4 v12, s[16:19], s39 offen offset:3072 lds
    s_mov_b32 s20, s48
    s_and_b32 s21, s49, 0xffff
    s_mov_b32 s22, 4194304
    s_mov_b32 s23, 0x00020000
    s_lshl_b32 s59, s2, 3
    s_add_u32 s59, s59, s24
    s_and_b32 s43, s59, 255
    s_lshr_b32 s59, s59, 8
    s_lshl_b32 s44, s43, 14
    s_lshl_b32 s50, s59, 7
    s_add_u32 s44, s44, s50
    v_lshrrev_b32 v14, 3, v1
    v_and_b32 v15, 7, v1
    v_lshlrev_b32 v15, 4, v15
    v_lshl_add_u32 v14, v14, 10, v15
    s_add_u32 m0, s35, 16384
    s_add_u32 s50, s44, 7168
    buffer_load_dwordx4 v14, s[20:23], s44 offen lds
    buffer_load_dwordx4 v14, s[20:23], s50 offen offset:1024 lds
    s_lshl_b32 s59, s59, 19
    s_lshl_b32 s43, s43, 10
    s_add_u32 s59, s59, s43
    s_add_u32 s59, s59, 67108864
    s_cmp_eq_u32 s25, 0
    s_cbranch_scc1 attn_kernel_np
    s_setprio 1
attn_kernel_np:
    v_and_b32 v10, 31, v1
    v_lshrrev_b32 v11, 5, v1
    s_mov_b32 s41, 0x3E0293EE
    s_mov_b32 s42, 0x42800000
    v_mov_b32 v4, 0
    v_mov_b32 v5, 0
    v_mov_b32 v6, 0
    v_mov_b32 v7, 0
    s_lshl_b32 s43, s26, 5
    s_lshl_b32 s44, s25, 6
    s_sub_i32 s43, s43, s44
    v_add_u32 v9, s43, v10
    v_lshlrev_b32 v14, 2, v11
    v_sub_u32 v9, v9, v14
    v_mov_b32 v16, 0
    v_mov_b32 v17, 0
    v_mov_b32 v18, 0
    v_mov_b32 v19, 0
    v_mov_b32 v20, 0
    v_mov_b32 v21, 0
    v_mov_b32 v22, 0
    v_mov_b32 v23, 0
    v_mov_b32 v24, 0
    v_mov_b32 v25, 0
    v_mov_b32 v26, 0
    v_mov_b32 v27, 0
    v_mov_b32 v28, 0
    v_mov_b32 v29, 0
    v_mov_b32 v30, 0
    v_mov_b32 v31, 0
    v_mov_b32 v32, 0
    v_mov_b32 v33, 0
    v_mov_b32 v34, 0
    v_mov_b32 v35, 0
    v_mov_b32 v36, 0
    v_mov_b32 v37, 0
    v_mov_b32 v38, 0
    v_mov_b32 v39, 0
    v_mov_b32 v40, 0
    v_mov_b32 v41, 0
    v_mov_b32 v42, 0
    v_mov_b32 v43, 0
    v_mov_b32 v44, 0
    v_mov_b32 v45, 0
    v_mov_b32 v46, 0
    v_mov_b32 v47, 0
    v_mov_b32 v48, 0
    v_mov_b32 v49, 0
    v_mov_b32 v50, 0
    v_mov_b32 v51, 0
    v_mov_b32 v52, 0
    v_mov_b32 v53, 0
    v_mov_b32 v54, 0
    v_mov_b32 v55, 0
    v_mov_b32 v56, 0
    v_mov_b32 v57, 0
    v_mov_b32 v58, 0
    v_mov_b32 v59, 0
    v_mov_b32 v60, 0
    v_mov_b32 v61, 0
    v_mov_b32 v62, 0
    v_mov_b32 v63, 0
    v_mov_b32 v64, 0
    v_mov_b32 v65, 0
    v_mov_b32 v66, 0
    v_mov_b32 v67, 0
    v_mov_b32 v68, 0
    v_mov_b32 v69, 0
    v_mov_b32 v70, 0
    v_mov_b32 v71, 0
    v_mov_b32 v72, 0
    v_mov_b32 v73, 0
    v_mov_b32 v74, 0
    v_mov_b32 v75, 0
    v_mov_b32 v76, 0
    v_mov_b32 v77, 0
    v_mov_b32 v78, 0
    v_mov_b32 v79, 0
    v_mov_b32 v2, 0
    v_mov_b32 v208, 0
    v_mov_b32 v209, 0
    v_mov_b32 v210, 0
    v_mov_b32 v211, 0
    v_mov_b32 v212, 0
    v_mov_b32 v213, 0
    v_mov_b32 v214, 0
    v_mov_b32 v215, 0
    v_mov_b32 v216, 0
    v_mov_b32 v217, 0
    v_mov_b32 v218, 0
    v_mov_b32 v219, 0
    v_mov_b32 v220, 0
    v_mov_b32 v221, 0
    v_mov_b32 v222, 0
    v_mov_b32 v223, 0
    s_mov_b64 s[54:55], -1
    s_mov_b32 s45, 0
    s_lshl_b32 s51, s26, 13
    s_add_u32 s51, s51, 131072
    s_sub_u32 s51, s51, s30
    s_waitcnt vmcnt(0)
    s_barrier
    v_add_u32 v14, s51, v13
    ds_read_b128 a[0:3], v14 offset:0
    ds_read_b128 a[4:7], v14 offset:1024
    ds_read_b128 a[8:11], v14 offset:2048
    ds_read_b128 a[12:15], v14 offset:3072
    ds_read_b128 a[16:19], v14 offset:4096
    ds_read_b128 a[20:23], v14 offset:5120
    ds_read_b128 a[24:27], v14 offset:6144
    ds_read_b128 a[28:31], v14 offset:7168
    s_add_u32 s38, s32, 32768
    s_add_u32 m0, s34, 16384
    s_nop 0
    buffer_load_dwordx4 v12, s[16:19], s38 offen lds
    buffer_load_dwordx4 v12, s[16:19], s38 offen offset:1024 lds
    buffer_load_dwordx4 v12, s[16:19], s38 offen offset:2048 lds
    buffer_load_dwordx4 v12, s[16:19], s38 offen offset:3072 lds
    s_add_u32 m0, s35, 0
    s_nop 0
    buffer_load_dwordx4 v12, s[16:19], s33 offen lds
    buffer_load_dwordx4 v12, s[16:19], s33 offen offset:1024 lds
    buffer_load_dwordx4 v12, s[16:19], s33 offen offset:2048 lds
    buffer_load_dwordx4 v12, s[16:19], s33 offen offset:3072 lds
    ds_read_b128 v[160:163], v13 offset:0
    ds_read_b128 v[164:167], v13 offset:1024
    ds_read_b128 v[168:171], v13 offset:2048
    ds_read_b128 v[172:175], v13 offset:3072
    ds_read_b128 v[176:179], v13 offset:4096
    ds_read_b128 v[180:183], v13 offset:5120
    s_waitcnt lgkmcnt(5)
    v_mfma_f32_32x32x16_bf16 v[80:95], v[160:163], a[0:3], v[208:223]
    ds_read_b128 v[160:163], v13 offset:6144
    s_waitcnt lgkmcnt(5)
    v_mfma_f32_32x32x16_bf16 v[80:95], v[164:167], a[4:7], v[80:95]
    ds_read_b128 v[164:167], v13 offset:7168
    s_waitcnt lgkmcnt(5)
    v_mfma_f32_32x32x16_bf16 v[80:95], v[168:171], a[8:11], v[80:95]
    ds_read_b128 v[168:171], v13 offset:8192
    s_waitcnt lgkmcnt(5)
    v_mfma_f32_32x32x16_bf16 v[80:95], v[172:175], a[12:15], v[80:95]
    ds_read_b128 v[172:175], v13 offset:9216
    s_waitcnt lgkmcnt(5)
    v_mfma_f32_32x32x16_bf16 v[80:95], v[176:179], a[16:19], v[80:95]
    ds_read_b128 v[176:179], v13 offset:10240
    s_waitcnt lgkmcnt(5)
    v_mfma_f32_32x32x16_bf16 v[80:95], v[180:183], a[20:23], v[80:95]
    ds_read_b128 v[180:183], v13 offset:11264
    s_waitcnt lgkmcnt(5)
    v_mfma_f32_32x32x16_bf16 v[80:95], v[160:163], a[24:27], v[80:95]
    ds_read_b128 v[160:163], v13 offset:12288
    s_waitcnt lgkmcnt(5)
    v_mfma_f32_32x32x16_bf16 v[80:95], v[164:167], a[28:31], v[80:95]
    ds_read_b128 v[164:167], v13 offset:13312
    s_waitcnt lgkmcnt(5)
    v_mfma_f32_32x32x16_bf16 v[96:111], v[168:171], a[0:3], v[208:223]
    ds_read_b128 v[168:171], v13 offset:14336
    s_waitcnt lgkmcnt(5)
    v_mfma_f32_32x32x16_bf16 v[96:111], v[172:175], a[4:7], v[96:111]
    ds_read_b128 v[172:175], v13 offset:15360
    s_waitcnt lgkmcnt(5)
    v_mfma_f32_32x32x16_bf16 v[96:111], v[176:179], a[8:11], v[96:111]
    s_waitcnt lgkmcnt(4)
    v_mfma_f32_32x32x16_bf16 v[96:111], v[180:183], a[12:15], v[96:111]
    s_waitcnt lgkmcnt(3)
    v_mfma_f32_32x32x16_bf16 v[96:111], v[160:163], a[16:19], v[96:111]
    s_waitcnt lgkmcnt(2)
    v_mfma_f32_32x32x16_bf16 v[96:111], v[164:167], a[20:23], v[96:111]
    s_waitcnt lgkmcnt(1)
    v_mfma_f32_32x32x16_bf16 v[96:111], v[168:171], a[24:27], v[96:111]
    s_waitcnt lgkmcnt(0)
    v_mfma_f32_32x32x16_bf16 v[96:111], v[172:175], a[28:31], v[96:111]
    v_lshrrev_b32 v14, 5, v1
    v_lshlrev_b32 v14, 2, v14
    v_bfe_u32 v15, v1, 2, 2
    v_add_u32 v14, v14, v15
    v_lshlrev_b32 v14, 7, v14
    v_bfe_u32 v15, v1, 4, 1
    v_lshl_add_u32 v14, v15, 5, v14
    v_and_b32 v15, 3, v1
    v_lshl_add_u32 v14, v15, 3, v14
    s_add_u32 s43, s35, 16384
    v_add_u32 v14, s43, v14
    ds_read_b64_tr_b16 v[184:185], v14 offset:0
    ds_read_b64_tr_b16 v[186:187], v14 offset:1024
    ds_read_b64_tr_b16 v[188:189], v14 offset:64
    ds_read_b64_tr_b16 v[190:191], v14 offset:1088
    s_add_u32 s43, s59, 262144
    s_waitcnt lgkmcnt(0)
    buffer_store_dwordx4 v[184:187], v12, s[16:19], s59 offen sc0 sc1
    buffer_store_dwordx4 v[188:191], v12, s[16:19], s43 offen sc0 sc1
    v_max_f32 v3, v80, v81
    v_max_f32 v8, v82, v83
    v_max3_f32 v3, v84, v85, v3
    v_max3_f32 v8, v86, v87, v8
    v_max3_f32 v3, v88, v89, v3
    v_max3_f32 v8, v90, v91, v8
    v_max3_f32 v3, v92, v93, v3
    v_max3_f32 v8, v94, v95, v8
    v_max3_f32 v3, v96, v97, v3
    v_max3_f32 v8, v98, v99, v8
    v_max3_f32 v3, v100, v101, v3
    v_max3_f32 v8, v102, v103, v8
    v_max3_f32 v3, v104, v105, v3
    v_max3_f32 v8, v106, v107, v8
    v_max3_f32 v3, v108, v109, v3
    v_max3_f32 v8, v110, v111, v8
    v_max_f32 v3, v3, v8
    v_mov_b32 v8, v3
    s_nop 1
    v_permlane32_swap_b32 v3, v8
    v_max_f32 v3, v3, v8
    v_cmp_lt_f32 vcc, s42, v3
    s_add_u32 s38, s32, 65536
    s_add_u32 s39, s33, 32768
    s_waitcnt vmcnt(2)
    s_barrier
    s_lshl_b32 s39, s28, 15
    s_lshl_b32 s44, s24, 12
    s_add_u32 s39, s39, s44
    s_add_u32 s39, s39, s29
    s_add_u32 s39, s39, 0
    s_add_u32 m0, s44, 131072
    s_nop 0
    buffer_load_dwordx4 v12, s[16:19], s39 offen offset:0 lds
    buffer_load_dwordx4 v12, s[16:19], s39 offen offset:1024 lds
    buffer_load_dwordx4 v12, s[16:19], s39 offen offset:2048 lds
    buffer_load_dwordx4 v12, s[16:19], s39 offen offset:3072 lds
    s_add_u32 s39, s33, 32768
    ds_read_b128 v[160:163], v13 offset:16384
    ds_read_b128 v[164:167], v13 offset:17408
    ds_read_b128 v[168:171], v13 offset:18432
    ds_read_b128 v[172:175], v13 offset:19456
    ds_read_b128 v[176:179], v13 offset:20480
attn_kernel_body0:
    s_or_b64 vcc, vcc, s[54:55]
    s_cbranch_vccz attn_kernel_norsb0
    s_nop 7
    s_nop 7
    v_max_f32 v8, 0, v3
    v_mov_b32 v14, 0xff800000
    v_cmp_eq_f32 vcc, v14, v3
    s_nop 1
    v_cndmask_b32 v3, v3, 0, vcc
    v_cndmask_b32 v3, v8, v3, s[54:55]
    v_sub_f32 v8, 0, v3
    v_exp_f32 v8, v8
    v_add_f32 v2, v2, v3
    v_cndmask_b32 v8, v8, 0, s[54:55]
    v_sub_f32 v14, 0, v2
    v_mul_f32 v16, v16, v8
    v_mul_f32 v17, v17, v8
    v_mul_f32 v18, v18, v8
    v_mul_f32 v19, v19, v8
    v_mul_f32 v20, v20, v8
    v_mul_f32 v21, v21, v8
    v_mul_f32 v22, v22, v8
    v_mul_f32 v23, v23, v8
    v_mul_f32 v24, v24, v8
    v_mul_f32 v25, v25, v8
    v_mul_f32 v26, v26, v8
    v_mul_f32 v27, v27, v8
    v_mul_f32 v28, v28, v8
    v_mul_f32 v29, v29, v8
    v_mul_f32 v30, v30, v8
    v_mul_f32 v31, v31, v8
    v_mul_f32 v32, v32, v8
    v_mul_f32 v33, v33, v8
    v_mul_f32 v34, v34, v8
    v_mul_f32 v35, v35, v8
    v_mul_f32 v36, v36, v8
    v_mul_f32 v37, v37, v8
    v_mul_f32 v38, v38, v8
    v_mul_f32 v39, v39, v8
    v_mul_f32 v40, v40, v8
    v_mul_f32 v41, v41, v8
    v_mul_f32 v42, v42, v8
    v_mul_f32 v43, v43, v8
    v_mul_f32 v44, v44, v8
    v_mul_f32 v45, v45, v8
    v_mul_f32 v46, v46, v8
    v_mul_f32 v47, v47, v8
    v_mul_f32 v48, v48, v8
    v_mul_f32 v49, v49, v8
    v_mul_f32 v50, v50, v8
    v_mul_f32 v51, v51, v8
    v_mul_f32 v52, v52, v8
    v_mul_f32 v53, v53, v8
    v_mul_f32 v54, v54, v8
    v_mul_f32 v55, v55, v8
    v_mul_f32 v56, v56, v8
    v_mul_f32 v57, v57, v8
    v_mul_f32 v58, v58, v8
    v_mul_f32 v59, v59, v8
    v_mul_f32 v60, v60, v8
    v_mul_f32 v61, v61, v8
    v_mul_f32 v62, v62, v8
    v_mul_f32 v63, v63, v8
    v_mul_f32 v64, v64, v8
    v_mul_f32 v65, v65, v8
    v_mul_f32 v66, v66, v8
    v_mul_f32 v67, v67, v8
    v_mul_f32 v68, v68, v8
    v_mul_f32 v69, v69, v8
    v_mul_f32 v70, v70, v8
    v_mul_f32 v71, v71, v8
    v_mul_f32 v72, v72, v8
    v_mul_f32 v73, v73, v8
    v_mul_f32 v74, v74, v8
    v_mul_f32 v75, v75, v8
    v_mul_f32 v76, v76, v8
    v_mul_f32 v77, v77, v8
    v_mul_f32 v78, v78, v8
    v_mul_f32 v79, v79, v8
    v_mul_f32 v4, v4, v8
    v_mul_f32 v5, v5, v8
    v_mul_f32 v6, v6, v8
    v_mul_f32 v7, v7, v8
    v_sub_f32 v80, v80, v3
    v_sub_f32 v81, v81, v3
    v_sub_f32 v82, v82, v3
    v_sub_f32 v83, v83, v3
    v_sub_f32 v84, v84, v3
    v_sub_f32 v85, v85, v3
    v_sub_f32 v86, v86, v3
    v_sub_f32 v87, v87, v3
    v_sub_f32 v88, v88, v3
    v_sub_f32 v89, v89, v3
    v_sub_f32 v90, v90, v3
    v_sub_f32 v91, v91, v3
    v_sub_f32 v92, v92, v3
    v_sub_f32 v93, v93, v3
    v_sub_f32 v94, v94, v3
    v_sub_f32 v95, v95, v3
    v_sub_f32 v96, v96, v3
    v_sub_f32 v97, v97, v3
    v_sub_f32 v98, v98, v3
    v_sub_f32 v99, v99, v3
    v_sub_f32 v100, v100, v3
    v_sub_f32 v101, v101, v3
    v_sub_f32 v102, v102, v3
    v_sub_f32 v103, v103, v3
    v_sub_f32 v104, v104, v3
    v_sub_f32 v105, v105, v3
    v_sub_f32 v106, v106, v3
    v_sub_f32 v107, v107, v3
    v_sub_f32 v108, v108, v3
    v_sub_f32 v109, v109, v3
    v_sub_f32 v110, v110, v3
    v_sub_f32 v111, v111, v3
    v_mov_b32 v208, v14
    v_mov_b32 v209, v14
    v_mov_b32 v210, v14
    v_mov_b32 v211, v14
    v_mov_b32 v212, v14
    v_mov_b32 v213, v14
    v_mov_b32 v214, v14
    v_mov_b32 v215, v14
    v_mov_b32 v216, v14
    v_mov_b32 v217, v14
    v_mov_b32 v218, v14
    v_mov_b32 v219, v14
    v_mov_b32 v220, v14
    v_mov_b32 v221, v14
    v_mov_b32 v222, v14
    v_mov_b32 v223, v14
    s_mov_b64 s[54:55], 0
    s_nop 1
attn_kernel_norsb0:
    s_cmp_lg_u32 s45, s37
    s_cbranch_scc1 attn_kernel_nq0
    v_add_u32 v14, s51, v13
    ds_read_b128 a[0:3], v14 offset:0
    ds_read_b128 a[4:7], v14 offset:1024
    ds_read_b128 a[8:11], v14 offset:2048
    ds_read_b128 a[12:15], v14 offset:3072
    ds_read_b128 a[16:19], v14 offset:4096
    ds_read_b128 a[20:23], v14 offset:5120
    ds_read_b128 a[24:27], v14 offset:6144
    ds_read_b128 a[28:31], v14 offset:7168
    s_waitcnt lgkmcnt(0)
attn_kernel_nq0:
    ds_read_b128 v[180:183], v13 offset:21504
    s_waitcnt lgkmcnt(4)
    v_mfma_f32_32x32x16_bf16 v[112:127], v[160:163], a[0:3], v[208:223]
    v_exp_f32 v80, v80
    v_exp_f32 v81, v81
    v_exp_f32 v82, v82
    v_exp_f32 v83, v83
    v_exp_f32 v84, v84
    ds_read_b128 v[160:163], v13 offset:22528
    v_mfma_f32_32x32x16_bf16 v[112:127], v[164:167], a[4:7], v[112:127]
    s_add_u32 m0, s35, 16384
    s_nop 0
    buffer_load_dwordx4 v12, s[16:19], s39 offen lds
    v_exp_f32 v85, v85
    v_exp_f32 v86, v86
    ds_read_b128 v[164:167], v13 offset:23552
    s_waitcnt lgkmcnt(4)
    v_mfma_f32_32x32x16_bf16 v[112:127], v[168:171], a[8:11], v[112:127]
    v_exp_f32 v87, v87
    v_cvt_pk_bf16_f32 v144, v80, v81
    ds_read_b128 v[168:171], v13 offset:24576
    v_mfma_f32_32x32x16_bf16 v[112:127], v[172:175], a[12:15], v[112:127]
    buffer_load_dwordx4 v12, s[16:19], s39 offen offset:1024 lds
    v_cvt_pk_bf16_f32 v145, v82, v83
    v_add_f32 v4, v4, v80
    v_add_f32 v5, v5, v81
    v_add_f32 v6, v6, v82
    v_add_f32 v7, v7, v83
    ds_read_b128 v[172:175], v13 offset:25600
    s_waitcnt lgkmcnt(4)
    v_mfma_f32_32x32x16_bf16 v[112:127], v[176:179], a[16:19], v[112:127]
    v_exp_f32 v88, v88
    v_exp_f32 v89, v89
    ds_read_b128 v[176:179], v13 offset:26624
    v_mfma_f32_32x32x16_bf16 v[112:127], v[180:183], a[20:23], v[112:127]
    buffer_load_dwordx4 v12, s[16:19], s39 offen offset:2048 lds
    v_exp_f32 v90, v90
    v_exp_f32 v91, v91
    ds_read_b128 v[180:183], v13 offset:27648
    s_waitcnt lgkmcnt(4)
    v_mfma_f32_32x32x16_bf16 v[112:127], v[160:163], a[24:27], v[112:127]
    v_cvt_pk_bf16_f32 v146, v84, v85
    v_cvt_pk_bf16_f32 v147, v86, v87
    v_add_f32 v4, v4, v84
    v_add_f32 v5, v5, v85
    v_add_f32 v6, v6, v86
    ds_read_b128 v[160:163], v13 offset:28672
    v_mfma_f32_32x32x16_bf16 v[112:127], v[164:167], a[28:31], v[112:127]
    buffer_load_dwordx4 v12, s[16:19], s39 offen offset:3072 lds
    v_add_f32 v7, v7, v87
    v_exp_f32 v92, v92
    v_exp_f32 v93, v93
    ds_read_b128 v[164:167], v13 offset:29696
    s_waitcnt lgkmcnt(4)
    v_mfma_f32_32x32x16_bf16 v[128:143], v[168:171], a[0:3], v[208:223]
    v_exp_f32 v94, v94
    v_exp_f32 v95, v95
    ds_read_b128 v[168:171], v13 offset:30720
    v_mfma_f32_32x32x16_bf16 v[128:143], v[172:175], a[4:7], v[128:143]
    s_add_u32 m0, s34, 0
    s_nop 0
    buffer_load_dwordx4 v12, s[16:19], s38 offen lds
    v_cvt_pk_bf16_f32 v148, v88, v89
    v_cvt_pk_bf16_f32 v149, v90, v91
    v_add_f32 v4, v4, v88
    v_add_f32 v5, v5, v89
    ds_read_b128 v[172:175], v13 offset:31744
    s_waitcnt lgkmcnt(4)
    v_mfma_f32_32x32x16_bf16 v[128:143], v[176:179], a[8:11], v[128:143]
    v_add_f32 v6, v6, v90
    v_add_f32 v7, v7, v91
    v_exp_f32 v96, v96
    ds_read_b128 v[184:187], v13 offset:32768
    v_mfma_f32_32x32x16_bf16 v[128:143], v[180:183], a[12:15], v[128:143]
    buffer_load_dwordx4 v12, s[16:19], s38 offen offset:1024 lds
    v_exp_f32 v97, v97
    v_exp_f32 v98, v98
    ds_read_b128 v[188:191], v13 offset:33792
    s_waitcnt lgkmcnt(4)
    v_mfma_f32_32x32x16_bf16 v[128:143], v[160:163], a[16:19], v[128:143]
    v_exp_f32 v99, v99
    v_cvt_pk_bf16_f32 v150, v92, v93
    v_cvt_pk_bf16_f32 v151, v94, v95
    v_add_f32 v4, v4, v92
    ds_read_b128 v[192:195], v13 offset:34816
    v_mfma_f32_32x32x16_bf16 v[128:143], v[164:167], a[20:23], v[128:143]
    buffer_load_dwordx4 v12, s[16:19], s38 offen offset:2048 lds
    v_add_f32 v5, v5, v93
    v_add_f32 v6, v6, v94
    v_add_f32 v7, v7, v95
    v_exp_f32 v100, v100
    ds_read_b128 v[196:199], v13 offset:35840
    s_waitcnt lgkmcnt(4)
    v_mfma_f32_32x32x16_bf16 v[128:143], v[168:171], a[24:27], v[128:143]
    v_exp_f32 v101, v101
    v_exp_f32 v102, v102
    ds_read_b128 v[200:203], v13 offset:36864
    v_mfma_f32_32x32x16_bf16 v[128:143], v[172:175], a[28:31], v[128:143]
    buffer_load_dwordx4 v12, s[16:19], s38 offen offset:3072 lds
    v_exp_f32 v103, v103
    v_cvt_pk_bf16_f32 v152, v96, v97
    v_cvt_pk_bf16_f32 v153, v98, v99
    ds_read_b128 v[204:207], v13 offset:37888
    s_waitcnt lgkmcnt(4)
    v_mfma_f32_32x32x16_bf16 v[16:31], v[184:187], v[144:147], v[16:31]
    v_add_f32 v4, v4, v96
    v_add_f32 v5, v5, v97
    v_add_f32 v6, v6, v98
    v_add_f32 v7, v7, v99
    ds_read_b128 v[184:187], v13 offset:38912
    v_mfma_f32_32x32x16_bf16 v[32:47], v[188:191], v[144:147], v[32:47]
    v_exp_f32 v104, v104
    v_exp_f32 v105, v105
    ds_read_b128 v[188:191], v13 offset:39936
    s_waitcnt lgkmcnt(4)
    v_mfma_f32_32x32x16_bf16 v[48:63], v[192:195], v[144:147], v[48:63]
    v_exp_f32 v106, v106
    v_exp_f32 v107, v107
    v_cvt_pk_bf16_f32 v154, v100, v101
    ds_read_b128 v[192:195], v13 offset:40960
    v_mfma_f32_32x32x16_bf16 v[64:79], v[196:199], v[144:147], v[64:79]
    v_cvt_pk_bf16_f32 v155, v102, v103
    v_add_f32 v4, v4, v100
    v_add_f32 v5, v5, v101
    v_add_f32 v6, v6, v102
    ds_read_b128 v[196:199], v13 offset:41984
    s_waitcnt lgkmcnt(4)
    v_mfma_f32_32x32x16_bf16 v[16:31], v[200:203], v[148:151], v[16:31]
    v_add_f32 v7, v7, v103
    v_exp_f32 v108, v108
    v_exp_f32 v109, v109
    ds_read_b128 v[200:203], v13 offset:43008
    v_mfma_f32_32x32x16_bf16 v[32:47], v[204:207], v[148:151], v[32:47]
    v_exp_f32 v110, v110
    v_exp_f32 v111, v111
    ds_read_b128 v[204:207], v13 offset:44032
    s_waitcnt lgkmcnt(4)
    v_mfma_f32_32x32x16_bf16 v[48:63], v[184:187], v[148:151], v[48:63]
    v_cvt_pk_bf16_f32 v156, v104, v105
    v_cvt_pk_bf16_f32 v157, v106, v107
    v_add_f32 v4, v4, v104
    v_add_f32 v5, v5, v105
    ds_read_b128 v[184:187], v13 offset:45056
    v_mfma_f32_32x32x16_bf16 v[64:79], v[188:191], v[148:151], v[64:79]
    v_add_f32 v6, v6, v106
    v_add_f32 v7, v7, v107
    s_nop 0
    v_cvt_pk_bf16_f32 v158, v108, v109
    v_cvt_pk_bf16_f32 v159, v110, v111
    ds_read_b128 v[188:191], v13 offset:46080
    s_waitcnt lgkmcnt(4)
    v_mfma_f32_32x32x16_bf16 v[16:31], v[192:195], v[152:155], v[16:31]
    v_add_f32 v4, v4, v108
    v_add_f32 v5, v5, v109
    v_add_f32 v6, v6, v110
    v_add_f32 v7, v7, v111
    ds_read_b128 v[192:195], v13 offset:47104
    v_mfma_f32_32x32x16_bf16 v[32:47], v[196:199], v[152:155], v[32:47]
    s_add_u32 s43, s45, 2
    s_cmp_gt_u32 s43, s37
    s_cselect_b32 s39, s58, 0
    s_sub_u32 s39, s43, s39
    s_lshl_b32 s39, s39, 15
    s_add_u32 s39, s39, s33
    s_add_u32 s43, s45, 3
    s_cmp_gt_u32 s43, s37
    s_cselect_b32 s38, s58, 0
    s_sub_u32 s38, s43, s38
    s_lshl_b32 s38, s38, 15
    s_add_u32 s38, s38, s32
    s_add_u32 s43, s45, 1
    s_cmp_eq_u32 s43, s37
    s_cselect_b32 s43, 16, s43
    s_cmp_lg_u32 s43, 16
    s_cbranch_scc1 attn_kernel_nm0
    v_mov_b32 v14, 0xff800000
    v_cmp_gt_i32 s[60:61], 0, v9
    v_cmp_gt_i32 s[62:63], 1, v9
    v_cmp_gt_i32 s[64:65], 2, v9
    v_cmp_gt_i32 s[66:67], 3, v9
    v_cmp_gt_i32 s[68:69], 8, v9
    v_cmp_gt_i32 s[70:71], 9, v9
    v_cmp_gt_i32 s[72:73], 10, v9
    v_cmp_gt_i32 s[74:75], 11, v9
    s_nop 1
    v_cndmask_b32 v112, v112, v14, s[60:61]
    v_cndmask_b32 v113, v113, v14, s[62:63]
    v_cndmask_b32 v114, v114, v14, s[64:65]
    v_cndmask_b32 v115, v115, v14, s[66:67]
    v_cndmask_b32 v116, v116, v14, s[68:69]
    v_cndmask_b32 v117, v117, v14, s[70:71]
    v_cndmask_b32 v118, v118, v14, s[72:73]
    v_cndmask_b32 v119, v119, v14, s[74:75]
    v_cmp_gt_i32 s[60:61], 16, v9
    v_cmp_gt_i32 s[62:63], 17, v9
    v_cmp_gt_i32 s[64:65], 18, v9
    v_cmp_gt_i32 s[66:67], 19, v9
    v_cmp_gt_i32 s[68:69], 24, v9
    v_cmp_gt_i32 s[70:71], 25, v9
    v_cmp_gt_i32 s[72:73], 26, v9
    v_cmp_gt_i32 s[74:75], 27, v9
    s_nop 1
    v_cndmask_b32 v120, v120, v14, s[60:61]
    v_cndmask_b32 v121, v121, v14, s[62:63]
    v_cndmask_b32 v122, v122, v14, s[64:65]
    v_cndmask_b32 v123, v123, v14, s[66:67]
    v_cndmask_b32 v124, v124, v14, s[68:69]
    v_cndmask_b32 v125, v125, v14, s[70:71]
    v_cndmask_b32 v126, v126, v14, s[72:73]
    v_cndmask_b32 v127, v127, v14, s[74:75]
    v_cmp_gt_i32 s[60:61], 32, v9
    v_cmp_gt_i32 s[62:63], 33, v9
    v_cmp_gt_i32 s[64:65], 34, v9
    v_cmp_gt_i32 s[66:67], 35, v9
    v_cmp_gt_i32 s[68:69], 40, v9
    v_cmp_gt_i32 s[70:71], 41, v9
    v_cmp_gt_i32 s[72:73], 42, v9
    v_cmp_gt_i32 s[74:75], 43, v9
    s_nop 1
    v_cndmask_b32 v128, v128, v14, s[60:61]
    v_cndmask_b32 v129, v129, v14, s[62:63]
    v_cndmask_b32 v130, v130, v14, s[64:65]
    v_cndmask_b32 v131, v131, v14, s[66:67]
    v_cndmask_b32 v132, v132, v14, s[68:69]
    v_cndmask_b32 v133, v133, v14, s[70:71]
    v_cndmask_b32 v134, v134, v14, s[72:73]
    v_cndmask_b32 v135, v135, v14, s[74:75]
    v_cmp_gt_i32 s[60:61], 48, v9
    v_cmp_gt_i32 s[62:63], 49, v9
    v_cmp_gt_i32 s[64:65], 50, v9
    v_cmp_gt_i32 s[66:67], 51, v9
    v_cmp_gt_i32 s[68:69], 56, v9
    v_cmp_gt_i32 s[70:71], 57, v9
    v_cmp_gt_i32 s[72:73], 58, v9
    v_cmp_gt_i32 s[74:75], 59, v9
    s_nop 1
    v_cndmask_b32 v136, v136, v14, s[60:61]
    v_cndmask_b32 v137, v137, v14, s[62:63]
    v_cndmask_b32 v138, v138, v14, s[64:65]
    v_cndmask_b32 v139, v139, v14, s[66:67]
    v_cndmask_b32 v140, v140, v14, s[68:69]
    v_cndmask_b32 v141, v141, v14, s[70:71]
    v_cndmask_b32 v142, v142, v14, s[72:73]
    v_cndmask_b32 v143, v143, v14, s[74:75]
attn_kernel_nm0:
    v_max_f32 v3, v112, v113
    v_max_f32 v8, v114, v115
    v_max3_f32 v3, v116, v117, v3
    v_max3_f32 v8, v118, v119, v8
    ds_read_b128 v[196:199], v13 offset:48128
    s_waitcnt lgkmcnt(4)
    v_mfma_f32_32x32x16_bf16 v[48:63], v[200:203], v[152:155], v[48:63]
    v_max3_f32 v3, v120, v121, v3
    v_max3_f32 v8, v122, v123, v8
    v_max3_f32 v3, v124, v125, v3
    v_max3_f32 v8, v126, v127, v8
    v_max3_f32 v3, v128, v129, v3
    v_mfma_f32_32x32x16_bf16 v[64:79], v[204:207], v[152:155], v[64:79]
    v_max3_f32 v8, v130, v131, v8
    v_max3_f32 v3, v132, v133, v3
    v_max3_f32 v8, v134, v135, v8
    v_max3_f32 v3, v136, v137, v3
    s_waitcnt lgkmcnt(2)
    v_mfma_f32_32x32x16_bf16 v[16:31], v[184:187], v[156:159], v[16:31]
    v_max3_f32 v8, v138, v139, v8
    v_max3_f32 v3, v140, v141, v3
    v_max3_f32 v8, v142, v143, v8
    v_max_f32 v3, v3, v8
    v_mfma_f32_32x32x16_bf16 v[32:47], v[188:191], v[156:159], v[32:47]
    v_mov_b32 v8, v3
    s_nop 1
    v_permlane32_swap_b32 v3, v8
    v_max_f32 v3, v3, v8
    v_cmp_lt_f32 vcc, s42, v3
    s_waitcnt vmcnt(0) lgkmcnt(0)
    s_barrier
    ds_read_b128 v[160:163], v13 offset:0
    ds_read_b128 v[164:167], v13 offset:1024
    ds_read_b128 v[168:171], v13 offset:2048
    ds_read_b128 v[172:175], v13 offset:3072
    ds_read_b128 v[176:179], v13 offset:4096
    v_mfma_f32_32x32x16_bf16 v[48:63], v[192:195], v[156:159], v[48:63]
    v_mfma_f32_32x32x16_bf16 v[64:79], v[196:199], v[156:159], v[64:79]
    s_mov_b32 s56, 0
    s_cmp_eq_u32 s45, s37
    s_cbranch_scc1 attn_kernel_merge
attn_kernel_cont0:
    s_add_u32 s45, s45, 1
    s_cmp_eq_u32 s45, 16
    s_cbranch_scc1 attn_kernel_tail1
attn_kernel_body1:
    s_or_b64 vcc, vcc, s[54:55]
    s_cbranch_vccz attn_kernel_norsb1
    s_nop 7
    s_nop 7
    v_max_f32 v8, 0, v3
    v_mov_b32 v14, 0xff800000
    v_cmp_eq_f32 vcc, v14, v3
    s_nop 1
    v_cndmask_b32 v3, v3, 0, vcc
    v_cndmask_b32 v3, v8, v3, s[54:55]
    v_sub_f32 v8, 0, v3
    v_exp_f32 v8, v8
    v_add_f32 v2, v2, v3
    v_cndmask_b32 v8, v8, 0, s[54:55]
    v_sub_f32 v14, 0, v2
    v_mul_f32 v16, v16, v8
    v_mul_f32 v17, v17, v8
    v_mul_f32 v18, v18, v8
    v_mul_f32 v19, v19, v8
    v_mul_f32 v20, v20, v8
    v_mul_f32 v21, v21, v8
    v_mul_f32 v22, v22, v8
    v_mul_f32 v23, v23, v8
    v_mul_f32 v24, v24, v8
    v_mul_f32 v25, v25, v8
    v_mul_f32 v26, v26, v8
    v_mul_f32 v27, v27, v8
    v_mul_f32 v28, v28, v8
    v_mul_f32 v29, v29, v8
    v_mul_f32 v30, v30, v8
    v_mul_f32 v31, v31, v8
    v_mul_f32 v32, v32, v8
    v_mul_f32 v33, v33, v8
    v_mul_f32 v34, v34, v8
    v_mul_f32 v35, v35, v8
    v_mul_f32 v36, v36, v8
    v_mul_f32 v37, v37, v8
    v_mul_f32 v38, v38, v8
    v_mul_f32 v39, v39, v8
    v_mul_f32 v40, v40, v8
    v_mul_f32 v41, v41, v8
    v_mul_f32 v42, v42, v8
    v_mul_f32 v43, v43, v8
    v_mul_f32 v44, v44, v8
    v_mul_f32 v45, v45, v8
    v_mul_f32 v46, v46, v8
    v_mul_f32 v47, v47, v8
    v_mul_f32 v48, v48, v8
    v_mul_f32 v49, v49, v8
    v_mul_f32 v50, v50, v8
    v_mul_f32 v51, v51, v8
    v_mul_f32 v52, v52, v8
    v_mul_f32 v53, v53, v8
    v_mul_f32 v54, v54, v8
    v_mul_f32 v55, v55, v8
    v_mul_f32 v56, v56, v8
    v_mul_f32 v57, v57, v8
    v_mul_f32 v58, v58, v8
    v_mul_f32 v59, v59, v8
    v_mul_f32 v60, v60, v8
    v_mul_f32 v61, v61, v8
    v_mul_f32 v62, v62, v8
    v_mul_f32 v63, v63, v8
    v_mul_f32 v64, v64, v8
    v_mul_f32 v65, v65, v8
    v_mul_f32 v66, v66, v8
    v_mul_f32 v67, v67, v8
    v_mul_f32 v68, v68, v8
    v_mul_f32 v69, v69, v8
    v_mul_f32 v70, v70, v8
    v_mul_f32 v71, v71, v8
    v_mul_f32 v72, v72, v8
    v_mul_f32 v73, v73, v8
    v_mul_f32 v74, v74, v8
    v_mul_f32 v75, v75, v8
    v_mul_f32 v76, v76, v8
    v_mul_f32 v77, v77, v8
    v_mul_f32 v78, v78, v8
    v_mul_f32 v79, v79, v8
    v_mul_f32 v4, v4, v8
    v_mul_f32 v5, v5, v8
    v_mul_f32 v6, v6, v8
    v_mul_f32 v7, v7, v8
    v_sub_f32 v112, v112, v3
    v_sub_f32 v113, v113, v3
    v_sub_f32 v114, v114, v3
    v_sub_f32 v115, v115, v3
    v_sub_f32 v116, v116, v3
    v_sub_f32 v117, v117, v3
    v_sub_f32 v118, v118, v3
    v_sub_f32 v119, v119, v3
    v_sub_f32 v120, v120, v3
    v_sub_f32 v121, v121, v3
    v_sub_f32 v122, v122, v3
    v_sub_f32 v123, v123, v3
    v_sub_f32 v124, v124, v3
    v_sub_f32 v125, v125, v3
    v_sub_f32 v126, v126, v3
    v_sub_f32 v127, v127, v3
    v_sub_f32 v128, v128, v3
    v_sub_f32 v129, v129, v3
    v_sub_f32 v130, v130, v3
    v_sub_f32 v131, v131, v3
    v_sub_f32 v132, v132, v3
    v_sub_f32 v133, v133, v3
    v_sub_f32 v134, v134, v3
    v_sub_f32 v135, v135, v3
    v_sub_f32 v136, v136, v3
    v_sub_f32 v137, v137, v3
    v_sub_f32 v138, v138, v3
    v_sub_f32 v139, v139, v3
    v_sub_f32 v140, v140, v3
    v_sub_f32 v141, v141, v3
    v_sub_f32 v142, v142, v3
    v_sub_f32 v143, v143, v3
    v_mov_b32 v208, v14
    v_mov_b32 v209, v14
    v_mov_b32 v210, v14
    v_mov_b32 v211, v14
    v_mov_b32 v212, v14
    v_mov_b32 v213, v14
    v_mov_b32 v214, v14
    v_mov_b32 v215, v14
    v_mov_b32 v216, v14
    v_mov_b32 v217, v14
    v_mov_b32 v218, v14
    v_mov_b32 v219, v14
    v_mov_b32 v220, v14
    v_mov_b32 v221, v14
    v_mov_b32 v222, v14
    v_mov_b32 v223, v14
    s_mov_b64 s[54:55], 0
    s_nop 1
attn_kernel_norsb1:
    s_cmp_lg_u32 s45, s37
    s_cbranch_scc1 attn_kernel_nq1
    v_add_u32 v14, s51, v13
    ds_read_b128 a[0:3], v14 offset:0
    ds_read_b128 a[4:7], v14 offset:1024
    ds_read_b128 a[8:11], v14 offset:2048
    ds_read_b128 a[12:15], v14 offset:3072
    ds_read_b128 a[16:19], v14 offset:4096
    ds_read_b128 a[20:23], v14 offset:5120
    ds_read_b128 a[24:27], v14 offset:6144
    ds_read_b128 a[28:31], v14 offset:7168
    s_waitcnt lgkmcnt(0)
attn_kernel_nq1:
    ds_read_b128 v[180:183], v13 offset:5120
    s_waitcnt lgkmcnt(4)
    v_mfma_f32_32x32x16_bf16 v[80:95], v[160:163], a[0:3], v[208:223]
    v_exp_f32 v112, v112
    v_exp_f32 v113, v113
    v_exp_f32 v114, v114
    v_exp_f32 v115, v115
    v_exp_f32 v116, v116
    ds_read_b128 v[160:163], v13 offset:6144
    v_mfma_f32_32x32x16_bf16 v[80:95], v[164:167], a[4:7], v[80:95]
    s_add_u32 m0, s35, 0
    s_nop 0
    buffer_load_dwordx4 v12, s[16:19], s39 offen lds
    v_exp_f32 v117, v117
    v_exp_f32 v118, v118
    ds_read_b128 v[164:167], v13 offset:7168
    s_waitcnt lgkmcnt(4)
    v_mfma_f32_32x32x16_bf16 v[80:95], v[168:171], a[8:11], v[80:95]
    v_exp_f32 v119, v119
    v_cvt_pk_bf16_f32 v144, v112, v113
    ds_read_b128 v[168:171], v13 offset:8192
    v_mfma_f32_32x32x16_bf16 v[80:95], v[172:175], a[12:15], v[80:95]
    buffer_load_dwordx4 v12, s[16:19], s39 offen offset:1024 lds
    v_cvt_pk_bf16_f32 v145, v114, v115
    v_add_f32 v4, v4, v112
    v_add_f32 v5, v5, v113
    v_add_f32 v6, v6, v114
    v_add_f32 v7, v7, v115
    ds_read_b128 v[172:175], v13 offset:9216
    s_waitcnt lgkmcnt(4)
    v_mfma_f32_32x32x16_bf16 v[80:95], v[176:179], a[16:19], v[80:95]
    v_exp_f32 v120, v120
    v_exp_f32 v121, v121
    ds_read_b128 v[176:179], v13 offset:10240
    v_mfma_f32_32x32x16_bf16 v[80:95], v[180:183], a[20:23], v[80:95]
    buffer_load_dwordx4 v12, s[16:19], s39 offen offset:2048 lds
    v_exp_f32 v122, v122
    v_exp_f32 v123, v123
    ds_read_b128 v[180:183], v13 offset:11264
    s_waitcnt lgkmcnt(4)
    v_mfma_f32_32x32x16_bf16 v[80:95], v[160:163], a[24:27], v[80:95]
    v_cvt_pk_bf16_f32 v146, v116, v117
    v_cvt_pk_bf16_f32 v147, v118, v119
    v_add_f32 v4, v4, v116
    v_add_f32 v5, v5, v117
    v_add_f32 v6, v6, v118
    ds_read_b128 v[160:163], v13 offset:12288
    v_mfma_f32_32x32x16_bf16 v[80:95], v[164:167], a[28:31], v[80:95]
    buffer_load_dwordx4 v12, s[16:19], s39 offen offset:3072 lds
    v_add_f32 v7, v7, v119
    v_exp_f32 v124, v124
    v_exp_f32 v125, v125
    ds_read_b128 v[164:167], v13 offset:13312
    s_waitcnt lgkmcnt(4)
    v_mfma_f32_32x32x16_bf16 v[96:111], v[168:171], a[0:3], v[208:223]
    v_exp_f32 v126, v126
    v_exp_f32 v127, v127
    ds_read_b128 v[168:171], v13 offset:14336
    v_mfma_f32_32x32x16_bf16 v[96:111], v[172:175], a[4:7], v[96:111]
    s_add_u32 m0, s34, 16384
    s_nop 0
    buffer_load_dwordx4 v12, s[16:19], s38 offen lds
    v_cvt_pk_bf16_f32 v148, v120, v121
    v_cvt_pk_bf16_f32 v149, v122, v123
    v_add_f32 v4, v4, v120
    v_add_f32 v5, v5, v121
    ds_read_b128 v[172:175], v13 offset:15360
    s_waitcnt lgkmcnt(4)
    v_mfma_f32_32x32x16_bf16 v[96:111], v[176:179], a[8:11], v[96:111]
    v_add_f32 v6, v6, v122
    v_add_f32 v7, v7, v123
    v_exp_f32 v128, v128
    ds_read_b128 v[184:187], v13 offset:49152
    v_mfma_f32_32x32x16_bf16 v[96:111], v[180:183], a[12:15], v[96:111]
    buffer_load_dwordx4 v12, s[16:19], s38 offen offset:1024 lds
    v_exp_f32 v129, v129
    v_exp_f32 v130, v130
    ds_read_b128 v[188:191], v13 offset:50176
    s_waitcnt lgkmcnt(4)
    v_mfma_f32_32x32x16_bf16 v[96:111], v[160:163], a[16:19], v[96:111]
    v_exp_f32 v131, v131
    v_cvt_pk_bf16_f32 v150, v124, v125
    v_cvt_pk_bf16_f32 v151, v126, v127
    v_add_f32 v4, v4, v124
    ds_read_b128 v[192:195], v13 offset:51200
    v_mfma_f32_32x32x16_bf16 v[96:111], v[164:167], a[20:23], v[96:111]
    buffer_load_dwordx4 v12, s[16:19], s38 offen offset:2048 lds
    v_add_f32 v5, v5, v125
    v_add_f32 v6, v6, v126
    v_add_f32 v7, v7, v127
    v_exp_f32 v132, v132
    ds_read_b128 v[196:199], v13 offset:52224
    s_waitcnt lgkmcnt(4)
    v_mfma_f32_32x32x16_bf16 v[96:111], v[168:171], a[24:27], v[96:111]
    v_exp_f32 v133, v133
    v_exp_f32 v134, v134
    ds_read_b128 v[200:203], v13 offset:53248
    v_mfma_f32_32x32x16_bf16 v[96:111], v[172:175], a[28:31], v[96:111]
    buffer_load_dwordx4 v12, s[16:19], s38 offen offset:3072 lds
    v_exp_f32 v135, v135
    v_cvt_pk_bf16_f32 v152, v128, v129
    v_cvt_pk_bf16_f32 v153, v130, v131
    ds_read_b128 v[204:207], v13 offset:54272
    s_waitcnt lgkmcnt(4)
    v_mfma_f32_32x32x16_bf16 v[16:31], v[184:187], v[144:147], v[16:31]
    v_add_f32 v4, v4, v128
    v_add_f32 v5, v5, v129
    v_add_f32 v6, v6, v130
    v_add_f32 v7, v7, v131
    ds_read_b128 v[184:187], v13 offset:55296
    v_mfma_f32_32x32x16_bf16 v[32:47], v[188:191], v[144:147], v[32:47]
    v_exp_f32 v136, v136
    v_exp_f32 v137, v137
    ds_read_b128 v[188:191], v13 offset:56320
    s_waitcnt lgkmcnt(4)
    v_mfma_f32_32x32x16_bf16 v[48:63], v[192:195], v[144:147], v[48:63]
    v_exp_f32 v138, v138
    v_exp_f32 v139, v139
    v_cvt_pk_bf16_f32 v154, v132, v133
    ds_read_b128 v[192:195], v13 offset:57344
    v_mfma_f32_32x32x16_bf16 v[64:79], v[196:199], v[144:147], v[64:79]
    v_cvt_pk_bf16_f32 v155, v134, v135
    v_add_f32 v4, v4, v132
    v_add_f32 v5, v5, v133
    v_add_f32 v6, v6, v134
    ds_read_b128 v[196:199], v13 offset:58368
    s_waitcnt lgkmcnt(4)
    v_mfma_f32_32x32x16_bf16 v[16:31], v[200:203], v[148:151], v[16:31]
    v_add_f32 v7, v7, v135
    v_exp_f32 v140, v140
    v_exp_f32 v141, v141
    ds_read_b128 v[200:203], v13 offset:59392
    v_mfma_f32_32x32x16_bf16 v[32:47], v[204:207], v[148:151], v[32:47]
    v_exp_f32 v142, v142
    v_exp_f32 v143, v143
    ds_read_b128 v[204:207], v13 offset:60416
    s_waitcnt lgkmcnt(4)
    v_mfma_f32_32x32x16_bf16 v[48:63], v[184:187], v[148:151], v[48:63]
    v_cvt_pk_bf16_f32 v156, v136, v137
    v_cvt_pk_bf16_f32 v157, v138, v139
    v_add_f32 v4, v4, v136
    v_add_f32 v5, v5, v137
    ds_read_b128 v[184:187], v13 offset:61440
    v_mfma_f32_32x32x16_bf16 v[64:79], v[188:191], v[148:151], v[64:79]
    v_add_f32 v6, v6, v138
    v_add_f32 v7, v7, v139
    s_nop 0
    v_cvt_pk_bf16_f32 v158, v140, v141
    v_cvt_pk_bf16_f32 v159, v142, v143
    ds_read_b128 v[188:191], v13 offset:62464
    s_waitcnt lgkmcnt(4)
    v_mfma_f32_32x32x16_bf16 v[16:31], v[192:195], v[152:155], v[16:31]
    v_add_f32 v4, v4, v140
    v_add_f32 v5, v5, v141
    v_add_f32 v6, v6, v142
    v_add_f32 v7, v7, v143
    ds_read_b128 v[192:195], v13 offset:63488
    v_mfma_f32_32x32x16_bf16 v[32:47], v[196:199], v[152:155], v[32:47]
    s_add_u32 s43, s45, 2
    s_cmp_gt_u32 s43, s37
    s_cselect_b32 s39, s58, 0
    s_sub_u32 s39, s43, s39
    s_lshl_b32 s39, s39, 15
    s_add_u32 s39, s39, s33
    s_add_u32 s43, s45, 3
    s_cmp_gt_u32 s43, s37
    s_cselect_b32 s38, s58, 0
    s_sub_u32 s38, s43, s38
    s_lshl_b32 s38, s38, 15
    s_add_u32 s38, s38, s32
    s_add_u32 s43, s45, 1
    s_cmp_eq_u32 s43, s37
    s_cselect_b32 s43, 16, s43
    s_cmp_lg_u32 s43, 16
    s_cbranch_scc1 attn_kernel_nm1
    v_mov_b32 v14, 0xff800000
    v_cmp_gt_i32 s[60:61], 0, v9
    v_cmp_gt_i32 s[62:63], 1, v9
    v_cmp_gt_i32 s[64:65], 2, v9
    v_cmp_gt_i32 s[66:67], 3, v9
    v_cmp_gt_i32 s[68:69], 8, v9
    v_cmp_gt_i32 s[70:71], 9, v9
    v_cmp_gt_i32 s[72:73], 10, v9
    v_cmp_gt_i32 s[74:75], 11, v9
    s_nop 1
    v_cndmask_b32 v80, v80, v14, s[60:61]
    v_cndmask_b32 v81, v81, v14, s[62:63]
    v_cndmask_b32 v82, v82, v14, s[64:65]
    v_cndmask_b32 v83, v83, v14, s[66:67]
    v_cndmask_b32 v84, v84, v14, s[68:69]
    v_cndmask_b32 v85, v85, v14, s[70:71]
    v_cndmask_b32 v86, v86, v14, s[72:73]
    v_cndmask_b32 v87, v87, v14, s[74:75]
    v_cmp_gt_i32 s[60:61], 16, v9
    v_cmp_gt_i32 s[62:63], 17, v9
    v_cmp_gt_i32 s[64:65], 18, v9
    v_cmp_gt_i32 s[66:67], 19, v9
    v_cmp_gt_i32 s[68:69], 24, v9
    v_cmp_gt_i32 s[70:71], 25, v9
    v_cmp_gt_i32 s[72:73], 26, v9
    v_cmp_gt_i32 s[74:75], 27, v9
    s_nop 1
    v_cndmask_b32 v88, v88, v14, s[60:61]
    v_cndmask_b32 v89, v89, v14, s[62:63]
    v_cndmask_b32 v90, v90, v14, s[64:65]
    v_cndmask_b32 v91, v91, v14, s[66:67]
    v_cndmask_b32 v92, v92, v14, s[68:69]
    v_cndmask_b32 v93, v93, v14, s[70:71]
    v_cndmask_b32 v94, v94, v14, s[72:73]
    v_cndmask_b32 v95, v95, v14, s[74:75]
    v_cmp_gt_i32 s[60:61], 32, v9
    v_cmp_gt_i32 s[62:63], 33, v9
    v_cmp_gt_i32 s[64:65], 34, v9
    v_cmp_gt_i32 s[66:67], 35, v9
    v_cmp_gt_i32 s[68:69], 40, v9
    v_cmp_gt_i32 s[70:71], 41, v9
    v_cmp_gt_i32 s[72:73], 42, v9
    v_cmp_gt_i32 s[74:75], 43, v9
    s_nop 1
    v_cndmask_b32 v96, v96, v14, s[60:61]
    v_cndmask_b32 v97, v97, v14, s[62:63]
    v_cndmask_b32 v98, v98, v14, s[64:65]
    v_cndmask_b32 v99, v99, v14, s[66:67]
    v_cndmask_b32 v100, v100, v14, s[68:69]
    v_cndmask_b32 v101, v101, v14, s[70:71]
    v_cndmask_b32 v102, v102, v14, s[72:73]
    v_cndmask_b32 v103, v103, v14, s[74:75]
    v_cmp_gt_i32 s[60:61], 48, v9
    v_cmp_gt_i32 s[62:63], 49, v9
    v_cmp_gt_i32 s[64:65], 50, v9
    v_cmp_gt_i32 s[66:67], 51, v9
    v_cmp_gt_i32 s[68:69], 56, v9
    v_cmp_gt_i32 s[70:71], 57, v9
    v_cmp_gt_i32 s[72:73], 58, v9
    v_cmp_gt_i32 s[74:75], 59, v9
    s_nop 1
    v_cndmask_b32 v104, v104, v14, s[60:61]
    v_cndmask_b32 v105, v105, v14, s[62:63]
    v_cndmask_b32 v106, v106, v14, s[64:65]
    v_cndmask_b32 v107, v107, v14, s[66:67]
    v_cndmask_b32 v108, v108, v14, s[68:69]
    v_cndmask_b32 v109, v109, v14, s[70:71]
    v_cndmask_b32 v110, v110, v14, s[72:73]
    v_cndmask_b32 v111, v111, v14, s[74:75]
attn_kernel_nm1:
    v_max_f32 v3, v80, v81
    v_max_f32 v8, v82, v83
    v_max3_f32 v3, v84, v85, v3
    v_max3_f32 v8, v86, v87, v8
    ds_read_b128 v[196:199], v13 offset:64512
    s_waitcnt lgkmcnt(4)
    v_mfma_f32_32x32x16_bf16 v[48:63], v[200:203], v[152:155], v[48:63]
    v_max3_f32 v3, v88, v89, v3
    v_max3_f32 v8, v90, v91, v8
    v_max3_f32 v3, v92, v93, v3
    v_max3_f32 v8, v94, v95, v8
    v_max3_f32 v3, v96, v97, v3
    v_mfma_f32_32x32x16_bf16 v[64:79], v[204:207], v[152:155], v[64:79]
    v_max3_f32 v8, v98, v99, v8
    v_max3_f32 v3, v100, v101, v3
    v_max3_f32 v8, v102, v103, v8
    v_max3_f32 v3, v104, v105, v3
    s_waitcnt lgkmcnt(2)
    v_mfma_f32_32x32x16_bf16 v[16:31], v[184:187], v[156:159], v[16:31]
    v_max3_f32 v8, v106, v107, v8
    v_max3_f32 v3, v108, v109, v3
    v_max3_f32 v8, v110, v111, v8
    v_max_f32 v3, v3, v8
    v_mfma_f32_32x32x16_bf16 v[32:47], v[188:191], v[156:159], v[32:47]
    v_mov_b32 v8, v3
    s_nop 1
    v_permlane32_swap_b32 v3, v8
    v_max_f32 v3, v3, v8
    v_cmp_lt_f32 vcc, s42, v3
    s_waitcnt vmcnt(0) lgkmcnt(0)
    s_barrier
    ds_read_b128 v[160:163], v13 offset:16384
    ds_read_b128 v[164:167], v13 offset:17408
    ds_read_b128 v[168:171], v13 offset:18432
    ds_read_b128 v[172:175], v13 offset:19456
    ds_read_b128 v[176:179], v13 offset:20480
    v_mfma_f32_32x32x16_bf16 v[48:63], v[192:195], v[156:159], v[48:63]
    v_mfma_f32_32x32x16_bf16 v[64:79], v[196:199], v[156:159], v[64:79]
    s_mov_b32 s56, 1
    s_cmp_eq_u32 s45, s37
    s_cbranch_scc1 attn_kernel_merge
attn_kernel_cont1:
    s_add_u32 s45, s45, 1
    s_cmp_eq_u32 s45, 16
    s_cbranch_scc1 attn_kernel_tail0
    s_branch attn_kernel_body0
attn_kernel_tail0:
    s_waitcnt lgkmcnt(0)
    s_lshr_b32 s43, s2, 3
    s_min_u32 s50, s43, 11
    s_lshr_b32 s50, s50, 1
    s_lshl_b32 s50, s50, 3
    s_add_u32 s50, s50, 56
    s_load_dwordx2 s[60:61], s[0:1], 48
    s_load_dwordx2 s[62:63], s[0:1], s50
    s_and_b32 s44, s2, 7
    v_and_b32 v14, 7, v1
    s_lshl_b32 s50, s43, 3
    s_add_u32 s50, s50, s24
    s_lshl_b32 s50, s50, 3
    v_add_u32 v14, s50, v14
    v_lshlrev_b32 v14, 10, v14
    s_lshl_b32 s50, s44, 7
    s_waitcnt lgkmcnt(0)
    s_mov_b32 s20, s60
    s_and_b32 s21, s61, 0xffff
    s_mov_b32 s22, 2097152
    s_mov_b32 s23, 0x00020000
    buffer_load_dword v160, v14, s[20:23], s50 offen
    s_cmp_ge_u32 s43, 12
    s_cbranch_scc1 attn_kernel_pf0
    s_cmp_lg_u32 s24, 7
    s_cbranch_scc1 attn_kernel_pf0
    s_lshl_b32 s50, s44, 14
    s_and_b32 s43, s43, 1
    s_lshl_b32 s43, s43, 13
    s_add_u32 s50, s50, s43
    v_lshlrev_b32 v14, 7, v1
    s_mov_b32 s20, s62
    s_and_b32 s21, s63, 0xffff
    s_mov_b32 s22, 131072
    s_mov_b32 s23, 0x00020000
    buffer_load_dword v161, v14, s[20:23], s50 offen
attn_kernel_pf0:
    s_or_b64 vcc, vcc, s[54:55]
    s_cbranch_vccz attn_kernel_norst0
    s_nop 7
    s_nop 7
    v_max_f32 v8, 0, v3
    v_mov_b32 v14, 0xff800000
    v_cmp_eq_f32 vcc, v14, v3
    s_nop 1
    v_cndmask_b32 v3, v3, 0, vcc
    v_cndmask_b32 v3, v8, v3, s[54:55]
    v_sub_f32 v8, 0, v3
    v_exp_f32 v8, v8
    v_add_f32 v2, v2, v3
    v_cndmask_b32 v8, v8, 0, s[54:55]
    v_sub_f32 v14, 0, v2
    v_mul_f32 v16, v16, v8
    v_mul_f32 v17, v17, v8
    v_mul_f32 v18, v18, v8
    v_mul_f32 v19, v19, v8
    v_mul_f32 v20, v20, v8
    v_mul_f32 v21, v21, v8
    v_mul_f32 v22, v22, v8
    v_mul_f32 v23, v23, v8
    v_mul_f32 v24, v24, v8
    v_mul_f32 v25, v25, v8
    v_mul_f32 v26, v26, v8
    v_mul_f32 v27, v27, v8
    v_mul_f32 v28, v28, v8
    v_mul_f32 v29, v29, v8
    v_mul_f32 v30, v30, v8
    v_mul_f32 v31, v31, v8
    v_mul_f32 v32, v32, v8
    v_mul_f32 v33, v33, v8
    v_mul_f32 v34, v34, v8
    v_mul_f32 v35, v35, v8
    v_mul_f32 v36, v36, v8
    v_mul_f32 v37, v37, v8
    v_mul_f32 v38, v38, v8
    v_mul_f32 v39, v39, v8
    v_mul_f32 v40, v40, v8
    v_mul_f32 v41, v41, v8
    v_mul_f32 v42, v42, v8
    v_mul_f32 v43, v43, v8
    v_mul_f32 v44, v44, v8
    v_mul_f32 v45, v45, v8
    v_mul_f32 v46, v46, v8
    v_mul_f32 v47, v47, v8
    v_mul_f32 v48, v48, v8
    v_mul_f32 v49, v49, v8
    v_mul_f32 v50, v50, v8
    v_mul_f32 v51, v51, v8
    v_mul_f32 v52, v52, v8
    v_mul_f32 v53, v53, v8
    v_mul_f32 v54, v54, v8
    v_mul_f32 v55, v55, v8
    v_mul_f32 v56, v56, v8
    v_mul_f32 v57, v57, v8
    v_mul_f32 v58, v58, v8
    v_mul_f32 v59, v59, v8
    v_mul_f32 v60, v60, v8
    v_mul_f32 v61, v61, v8
    v_mul_f32 v62, v62, v8
    v_mul_f32 v63, v63, v8
    v_mul_f32 v64, v64, v8
    v_mul_f32 v65, v65, v8
    v_mul_f32 v66, v66, v8
    v_mul_f32 v67, v67, v8
    v_mul_f32 v68, v68, v8
    v_mul_f32 v69, v69, v8
    v_mul_f32 v70, v70, v8
    v_mul_f32 v71, v71, v8
    v_mul_f32 v72, v72, v8
    v_mul_f32 v73, v73, v8
    v_mul_f32 v74, v74, v8
    v_mul_f32 v75, v75, v8
    v_mul_f32 v76, v76, v8
    v_mul_f32 v77, v77, v8
    v_mul_f32 v78, v78, v8
    v_mul_f32 v79, v79, v8
    v_mul_f32 v4, v4, v8
    v_mul_f32 v5, v5, v8
    v_mul_f32 v6, v6, v8
    v_mul_f32 v7, v7, v8
    v_sub_f32 v80, v80, v3
    v_sub_f32 v81, v81, v3
    v_sub_f32 v82, v82, v3
    v_sub_f32 v83, v83, v3
    v_sub_f32 v84, v84, v3
    v_sub_f32 v85, v85, v3
    v_sub_f32 v86, v86, v3
    v_sub_f32 v87, v87, v3
    v_sub_f32 v88, v88, v3
    v_sub_f32 v89, v89, v3
    v_sub_f32 v90, v90, v3
    v_sub_f32 v91, v91, v3
    v_sub_f32 v92, v92, v3
    v_sub_f32 v93, v93, v3
    v_sub_f32 v94, v94, v3
    v_sub_f32 v95, v95, v3
    v_sub_f32 v96, v96, v3
    v_sub_f32 v97, v97, v3
    v_sub_f32 v98, v98, v3
    v_sub_f32 v99, v99, v3
    v_sub_f32 v100, v100, v3
    v_sub_f32 v101, v101, v3
    v_sub_f32 v102, v102, v3
    v_sub_f32 v103, v103, v3
    v_sub_f32 v104, v104, v3
    v_sub_f32 v105, v105, v3
    v_sub_f32 v106, v106, v3
    v_sub_f32 v107, v107, v3
    v_sub_f32 v108, v108, v3
    v_sub_f32 v109, v109, v3
    v_sub_f32 v110, v110, v3
    v_sub_f32 v111, v111, v3
    v_mov_b32 v208, v14
    v_mov_b32 v209, v14
    v_mov_b32 v210, v14
    v_mov_b32 v211, v14
    v_mov_b32 v212, v14
    v_mov_b32 v213, v14
    v_mov_b32 v214, v14
    v_mov_b32 v215, v14
    v_mov_b32 v216, v14
    v_mov_b32 v217, v14
    v_mov_b32 v218, v14
    v_mov_b32 v219, v14
    v_mov_b32 v220, v14
    v_mov_b32 v221, v14
    v_mov_b32 v222, v14
    v_mov_b32 v223, v14
    s_mov_b64 s[54:55], 0
    s_nop 1
attn_kernel_norst0:
    ds_read_b128 v[184:187], v13 offset:32768
    ds_read_b128 v[188:191], v13 offset:33792
    ds_read_b128 v[192:195], v13 offset:34816
    ds_read_b128 v[196:199], v13 offset:35840
    ds_read_b128 v[200:203], v13 offset:36864
    v_exp_f32 v80, v80
    v_exp_f32 v81, v81
    v_exp_f32 v82, v82
    v_exp_f32 v83, v83
    v_exp_f32 v84, v84
    v_exp_f32 v85, v85
    v_exp_f32 v86, v86
    v_exp_f32 v87, v87
    v_cvt_pk_bf16_f32 v144, v80, v81
    v_cvt_pk_bf16_f32 v145, v82, v83
    v_add_f32 v4, v4, v80
    v_add_f32 v5, v5, v81
    v_add_f32 v6, v6, v82
    v_add_f32 v7, v7, v83
    v_exp_f32 v88, v88
    v_exp_f32 v89, v89
    v_exp_f32 v90, v90
    v_exp_f32 v91, v91
    v_cvt_pk_bf16_f32 v146, v84, v85
    v_cvt_pk_bf16_f32 v147, v86, v87
    v_add_f32 v4, v4, v84
    v_add_f32 v5, v5, v85
    v_add_f32 v6, v6, v86
    v_add_f32 v7, v7, v87
    v_exp_f32 v92, v92
    v_exp_f32 v93, v93
    v_exp_f32 v94, v94
    v_exp_f32 v95, v95
    v_cvt_pk_bf16_f32 v148, v88, v89
    v_cvt_pk_bf16_f32 v149, v90, v91
    v_add_f32 v4, v4, v88
    v_add_f32 v5, v5, v89
    v_add_f32 v6, v6, v90
    v_add_f32 v7, v7, v91
    v_exp_f32 v96, v96
    v_exp_f32 v97, v97
    v_exp_f32 v98, v98
    v_exp_f32 v99, v99
    v_cvt_pk_bf16_f32 v150, v92, v93
    v_cvt_pk_bf16_f32 v151, v94, v95
    v_add_f32 v4, v4, v92
    v_add_f32 v5, v5, v93
    v_add_f32 v6, v6, v94
    v_add_f32 v7, v7, v95
    v_exp_f32 v100, v100
    v_exp_f32 v101, v101
    v_exp_f32 v102, v102
    v_exp_f32 v103, v103
    v_cvt_pk_bf16_f32 v152, v96, v97
    v_cvt_pk_bf16_f32 v153, v98, v99
    v_add_f32 v4, v4, v96
    v_add_f32 v5, v5, v97
    v_add_f32 v6, v6, v98
    v_add_f32 v7, v7, v99
    v_exp_f32 v104, v104
    v_exp_f32 v105, v105
    v_exp_f32 v106, v106
    v_exp_f32 v107, v107
    v_cvt_pk_bf16_f32 v154, v100, v101
    v_cvt_pk_bf16_f32 v155, v102, v103
    v_add_f32 v4, v4, v100
    v_add_f32 v5, v5, v101
    v_add_f32 v6, v6, v102
    v_add_f32 v7, v7, v103
    v_exp_f32 v108, v108
    v_exp_f32 v109, v109
    v_exp_f32 v110, v110
    v_exp_f32 v111, v111
    v_cvt_pk_bf16_f32 v156, v104, v105
    v_cvt_pk_bf16_f32 v157, v106, v107
    v_add_f32 v4, v4, v104
    v_add_f32 v5, v5, v105
    v_add_f32 v6, v6, v106
    v_add_f32 v7, v7, v107
    s_nop 0
    v_cvt_pk_bf16_f32 v158, v108, v109
    v_cvt_pk_bf16_f32 v159, v110, v111
    v_add_f32 v4, v4, v108
    v_add_f32 v5, v5, v109
    v_add_f32 v6, v6, v110
    v_add_f32 v7, v7, v111
    s_nop 1
    ds_read_b128 v[204:207], v13 offset:37888
    s_waitcnt lgkmcnt(4)
    v_mfma_f32_32x32x16_bf16 v[16:31], v[184:187], v[144:147], v[16:31]
    ds_read_b128 v[184:187], v13 offset:38912
    v_mfma_f32_32x32x16_bf16 v[32:47], v[188:191], v[144:147], v[32:47]
    ds_read_b128 v[188:191], v13 offset:39936
    s_waitcnt lgkmcnt(4)
    v_mfma_f32_32x32x16_bf16 v[48:63], v[192:195], v[144:147], v[48:63]
    ds_read_b128 v[192:195], v13 offset:40960
    v_mfma_f32_32x32x16_bf16 v[64:79], v[196:199], v[144:147], v[64:79]
    ds_read_b128 v[196:199], v13 offset:41984
    s_waitcnt lgkmcnt(4)
    v_mfma_f32_32x32x16_bf16 v[16:31], v[200:203], v[148:151], v[16:31]
    ds_read_b128 v[200:203], v13 offset:43008
    v_mfma_f32_32x32x16_bf16 v[32:47], v[204:207], v[148:151], v[32:47]
    ds_read_b128 v[204:207], v13 offset:44032
    s_waitcnt lgkmcnt(4)
    v_mfma_f32_32x32x16_bf16 v[48:63], v[184:187], v[148:151], v[48:63]
    ds_read_b128 v[184:187], v13 offset:45056
    v_mfma_f32_32x32x16_bf16 v[64:79], v[188:191], v[148:151], v[64:79]
    ds_read_b128 v[188:191], v13 offset:46080
    s_waitcnt lgkmcnt(4)
    v_mfma_f32_32x32x16_bf16 v[16:31], v[192:195], v[152:155], v[16:31]
    ds_read_b128 v[192:195], v13 offset:47104
    v_mfma_f32_32x32x16_bf16 v[32:47], v[196:199], v[152:155], v[32:47]
    ds_read_b128 v[196:199], v13 offset:48128
    s_waitcnt lgkmcnt(4)
    v_mfma_f32_32x32x16_bf16 v[48:63], v[200:203], v[152:155], v[48:63]
    v_mfma_f32_32x32x16_bf16 v[64:79], v[204:207], v[152:155], v[64:79]
    s_waitcnt lgkmcnt(2)
    v_mfma_f32_32x32x16_bf16 v[16:31], v[184:187], v[156:159], v[16:31]
    v_mfma_f32_32x32x16_bf16 v[32:47], v[188:191], v[156:159], v[32:47]
    s_waitcnt lgkmcnt(0)
    v_mfma_f32_32x32x16_bf16 v[48:63], v[192:195], v[156:159], v[48:63]
    v_mfma_f32_32x32x16_bf16 v[64:79], v[196:199], v[156:159], v[64:79]
    s_mov_b32 s56, 0
    s_mov_b32 s37, s28
    s_branch attn_kernel_merge
attn_kernel_tail1:
    s_waitcnt lgkmcnt(0)
    s_lshr_b32 s43, s2, 3
    s_min_u32 s50, s43, 11
    s_lshr_b32 s50, s50, 1
    s_lshl_b32 s50, s50, 3
    s_add_u32 s50, s50, 56
    s_load_dwordx2 s[60:61], s[0:1], 48
    s_load_dwordx2 s[62:63], s[0:1], s50
    s_and_b32 s44, s2, 7
    v_and_b32 v14, 7, v1
    s_lshl_b32 s50, s43, 3
    s_add_u32 s50, s50, s24
    s_lshl_b32 s50, s50, 3
    v_add_u32 v14, s50, v14
    v_lshlrev_b32 v14, 10, v14
    s_lshl_b32 s50, s44, 7
    s_waitcnt lgkmcnt(0)
    s_mov_b32 s20, s60
    s_and_b32 s21, s61, 0xffff
    s_mov_b32 s22, 2097152
    s_mov_b32 s23, 0x00020000
    buffer_load_dword v160, v14, s[20:23], s50 offen
    s_cmp_ge_u32 s43, 12
    s_cbranch_scc1 attn_kernel_pf1
    s_cmp_lg_u32 s24, 7
    s_cbranch_scc1 attn_kernel_pf1
    s_lshl_b32 s50, s44, 14
    s_and_b32 s43, s43, 1
    s_lshl_b32 s43, s43, 13
    s_add_u32 s50, s50, s43
    v_lshlrev_b32 v14, 7, v1
    s_mov_b32 s20, s62
    s_and_b32 s21, s63, 0xffff
    s_mov_b32 s22, 131072
    s_mov_b32 s23, 0x00020000
    buffer_load_dword v161, v14, s[20:23], s50 offen
attn_kernel_pf1:
    s_or_b64 vcc, vcc, s[54:55]
    s_cbranch_vccz attn_kernel_norst1
    s_nop 7
    s_nop 7
    v_max_f32 v8, 0, v3
    v_mov_b32 v14, 0xff800000
    v_cmp_eq_f32 vcc, v14, v3
    s_nop 1
    v_cndmask_b32 v3, v3, 0, vcc
    v_cndmask_b32 v3, v8, v3, s[54:55]
    v_sub_f32 v8, 0, v3
    v_exp_f32 v8, v8
    v_add_f32 v2, v2, v3
    v_cndmask_b32 v8, v8, 0, s[54:55]
    v_sub_f32 v14, 0, v2
    v_mul_f32 v16, v16, v8
    v_mul_f32 v17, v17, v8
    v_mul_f32 v18, v18, v8
    v_mul_f32 v19, v19, v8
    v_mul_f32 v20, v20, v8
    v_mul_f32 v21, v21, v8
    v_mul_f32 v22, v22, v8
    v_mul_f32 v23, v23, v8
    v_mul_f32 v24, v24, v8
    v_mul_f32 v25, v25, v8
    v_mul_f32 v26, v26, v8
    v_mul_f32 v27, v27, v8
    v_mul_f32 v28, v28, v8
    v_mul_f32 v29, v29, v8
    v_mul_f32 v30, v30, v8
    v_mul_f32 v31, v31, v8
    v_mul_f32 v32, v32, v8
    v_mul_f32 v33, v33, v8
    v_mul_f32 v34, v34, v8
    v_mul_f32 v35, v35, v8
    v_mul_f32 v36, v36, v8
    v_mul_f32 v37, v37, v8
    v_mul_f32 v38, v38, v8
    v_mul_f32 v39, v39, v8
    v_mul_f32 v40, v40, v8
    v_mul_f32 v41, v41, v8
    v_mul_f32 v42, v42, v8
    v_mul_f32 v43, v43, v8
    v_mul_f32 v44, v44, v8
    v_mul_f32 v45, v45, v8
    v_mul_f32 v46, v46, v8
    v_mul_f32 v47, v47, v8
    v_mul_f32 v48, v48, v8
    v_mul_f32 v49, v49, v8
    v_mul_f32 v50, v50, v8
    v_mul_f32 v51, v51, v8
    v_mul_f32 v52, v52, v8
    v_mul_f32 v53, v53, v8
    v_mul_f32 v54, v54, v8
    v_mul_f32 v55, v55, v8
    v_mul_f32 v56, v56, v8
    v_mul_f32 v57, v57, v8
    v_mul_f32 v58, v58, v8
    v_mul_f32 v59, v59, v8
    v_mul_f32 v60, v60, v8
    v_mul_f32 v61, v61, v8
    v_mul_f32 v62, v62, v8
    v_mul_f32 v63, v63, v8
    v_mul_f32 v64, v64, v8
    v_mul_f32 v65, v65, v8
    v_mul_f32 v66, v66, v8
    v_mul_f32 v67, v67, v8
    v_mul_f32 v68, v68, v8
    v_mul_f32 v69, v69, v8
    v_mul_f32 v70, v70, v8
    v_mul_f32 v71, v71, v8
    v_mul_f32 v72, v72, v8
    v_mul_f32 v73, v73, v8
    v_mul_f32 v74, v74, v8
    v_mul_f32 v75, v75, v8
    v_mul_f32 v76, v76, v8
    v_mul_f32 v77, v77, v8
    v_mul_f32 v78, v78, v8
    v_mul_f32 v79, v79, v8
    v_mul_f32 v4, v4, v8
    v_mul_f32 v5, v5, v8
    v_mul_f32 v6, v6, v8
    v_mul_f32 v7, v7, v8
    v_sub_f32 v112, v112, v3
    v_sub_f32 v113, v113, v3
    v_sub_f32 v114, v114, v3
    v_sub_f32 v115, v115, v3
    v_sub_f32 v116, v116, v3
    v_sub_f32 v117, v117, v3
    v_sub_f32 v118, v118, v3
    v_sub_f32 v119, v119, v3
    v_sub_f32 v120, v120, v3
    v_sub_f32 v121, v121, v3
    v_sub_f32 v122, v122, v3
    v_sub_f32 v123, v123, v3
    v_sub_f32 v124, v124, v3
    v_sub_f32 v125, v125, v3
    v_sub_f32 v126, v126, v3
    v_sub_f32 v127, v127, v3
    v_sub_f32 v128, v128, v3
    v_sub_f32 v129, v129, v3
    v_sub_f32 v130, v130, v3
    v_sub_f32 v131, v131, v3
    v_sub_f32 v132, v132, v3
    v_sub_f32 v133, v133, v3
    v_sub_f32 v134, v134, v3
    v_sub_f32 v135, v135, v3
    v_sub_f32 v136, v136, v3
    v_sub_f32 v137, v137, v3
    v_sub_f32 v138, v138, v3
    v_sub_f32 v139, v139, v3
    v_sub_f32 v140, v140, v3
    v_sub_f32 v141, v141, v3
    v_sub_f32 v142, v142, v3
    v_sub_f32 v143, v143, v3
    v_mov_b32 v208, v14
    v_mov_b32 v209, v14
    v_mov_b32 v210, v14
    v_mov_b32 v211, v14
    v_mov_b32 v212, v14
    v_mov_b32 v213, v14
    v_mov_b32 v214, v14
    v_mov_b32 v215, v14
    v_mov_b32 v216, v14
    v_mov_b32 v217, v14
    v_mov_b32 v218, v14
    v_mov_b32 v219, v14
    v_mov_b32 v220, v14
    v_mov_b32 v221, v14
    v_mov_b32 v222, v14
    v_mov_b32 v223, v14
    s_mov_b64 s[54:55], 0
    s_nop 1
attn_kernel_norst1:
    ds_read_b128 v[184:187], v13 offset:49152
    ds_read_b128 v[188:191], v13 offset:50176
    ds_read_b128 v[192:195], v13 offset:51200
    ds_read_b128 v[196:199], v13 offset:52224
    ds_read_b128 v[200:203], v13 offset:53248
    v_exp_f32 v112, v112
    v_exp_f32 v113, v113
    v_exp_f32 v114, v114
    v_exp_f32 v115, v115
    v_exp_f32 v116, v116
    v_exp_f32 v117, v117
    v_exp_f32 v118, v118
    v_exp_f32 v119, v119
    v_cvt_pk_bf16_f32 v144, v112, v113
    v_cvt_pk_bf16_f32 v145, v114, v115
    v_add_f32 v4, v4, v112
    v_add_f32 v5, v5, v113
    v_add_f32 v6, v6, v114
    v_add_f32 v7, v7, v115
    v_exp_f32 v120, v120
    v_exp_f32 v121, v121
    v_exp_f32 v122, v122
    v_exp_f32 v123, v123
    v_cvt_pk_bf16_f32 v146, v116, v117
    v_cvt_pk_bf16_f32 v147, v118, v119
    v_add_f32 v4, v4, v116
    v_add_f32 v5, v5, v117
    v_add_f32 v6, v6, v118
    v_add_f32 v7, v7, v119
    v_exp_f32 v124, v124
    v_exp_f32 v125, v125
    v_exp_f32 v126, v126
    v_exp_f32 v127, v127
    v_cvt_pk_bf16_f32 v148, v120, v121
    v_cvt_pk_bf16_f32 v149, v122, v123
    v_add_f32 v4, v4, v120
    v_add_f32 v5, v5, v121
    v_add_f32 v6, v6, v122
    v_add_f32 v7, v7, v123
    v_exp_f32 v128, v128
    v_exp_f32 v129, v129
    v_exp_f32 v130, v130
    v_exp_f32 v131, v131
    v_cvt_pk_bf16_f32 v150, v124, v125
    v_cvt_pk_bf16_f32 v151, v126, v127
    v_add_f32 v4, v4, v124
    v_add_f32 v5, v5, v125
    v_add_f32 v6, v6, v126
    v_add_f32 v7, v7, v127
    v_exp_f32 v132, v132
    v_exp_f32 v133, v133
    v_exp_f32 v134, v134
    v_exp_f32 v135, v135
    v_cvt_pk_bf16_f32 v152, v128, v129
    v_cvt_pk_bf16_f32 v153, v130, v131
    v_add_f32 v4, v4, v128
    v_add_f32 v5, v5, v129
    v_add_f32 v6, v6, v130
    v_add_f32 v7, v7, v131
    v_exp_f32 v136, v136
    v_exp_f32 v137, v137
    v_exp_f32 v138, v138
    v_exp_f32 v139, v139
    v_cvt_pk_bf16_f32 v154, v132, v133
    v_cvt_pk_bf16_f32 v155, v134, v135
    v_add_f32 v4, v4, v132
    v_add_f32 v5, v5, v133
    v_add_f32 v6, v6, v134
    v_add_f32 v7, v7, v135
    v_exp_f32 v140, v140
    v_exp_f32 v141, v141
    v_exp_f32 v142, v142
    v_exp_f32 v143, v143
    v_cvt_pk_bf16_f32 v156, v136, v137
    v_cvt_pk_bf16_f32 v157, v138, v139
    v_add_f32 v4, v4, v136
    v_add_f32 v5, v5, v137
    v_add_f32 v6, v6, v138
    v_add_f32 v7, v7, v139
    s_nop 0
    v_cvt_pk_bf16_f32 v158, v140, v141
    v_cvt_pk_bf16_f32 v159, v142, v143
    v_add_f32 v4, v4, v140
    v_add_f32 v5, v5, v141
    v_add_f32 v6, v6, v142
    v_add_f32 v7, v7, v143
    s_nop 1
    ds_read_b128 v[204:207], v13 offset:54272
    s_waitcnt lgkmcnt(4)
    v_mfma_f32_32x32x16_bf16 v[16:31], v[184:187], v[144:147], v[16:31]
    ds_read_b128 v[184:187], v13 offset:55296
    v_mfma_f32_32x32x16_bf16 v[32:47], v[188:191], v[144:147], v[32:47]
    ds_read_b128 v[188:191], v13 offset:56320
    s_waitcnt lgkmcnt(4)
    v_mfma_f32_32x32x16_bf16 v[48:63], v[192:195], v[144:147], v[48:63]
    ds_read_b128 v[192:195], v13 offset:57344
    v_mfma_f32_32x32x16_bf16 v[64:79], v[196:199], v[144:147], v[64:79]
    ds_read_b128 v[196:199], v13 offset:58368
    s_waitcnt lgkmcnt(4)
    v_mfma_f32_32x32x16_bf16 v[16:31], v[200:203], v[148:151], v[16:31]
    ds_read_b128 v[200:203], v13 offset:59392
    v_mfma_f32_32x32x16_bf16 v[32:47], v[204:207], v[148:151], v[32:47]
    ds_read_b128 v[204:207], v13 offset:60416
    s_waitcnt lgkmcnt(4)
    v_mfma_f32_32x32x16_bf16 v[48:63], v[184:187], v[148:151], v[48:63]
    ds_read_b128 v[184:187], v13 offset:61440
    v_mfma_f32_32x32x16_bf16 v[64:79], v[188:191], v[148:151], v[64:79]
    ds_read_b128 v[188:191], v13 offset:62464
    s_waitcnt lgkmcnt(4)
    v_mfma_f32_32x32x16_bf16 v[16:31], v[192:195], v[152:155], v[16:31]
    ds_read_b128 v[192:195], v13 offset:63488
    v_mfma_f32_32x32x16_bf16 v[32:47], v[196:199], v[152:155], v[32:47]
    ds_read_b128 v[196:199], v13 offset:64512
    s_waitcnt lgkmcnt(4)
    v_mfma_f32_32x32x16_bf16 v[48:63], v[200:203], v[152:155], v[48:63]
    v_mfma_f32_32x32x16_bf16 v[64:79], v[204:207], v[152:155], v[64:79]
    s_waitcnt lgkmcnt(2)
    v_mfma_f32_32x32x16_bf16 v[16:31], v[184:187], v[156:159], v[16:31]
    v_mfma_f32_32x32x16_bf16 v[32:47], v[188:191], v[156:159], v[32:47]
    s_waitcnt lgkmcnt(0)
    v_mfma_f32_32x32x16_bf16 v[48:63], v[192:195], v[156:159], v[48:63]
    v_mfma_f32_32x32x16_bf16 v[64:79], v[196:199], v[156:159], v[64:79]
    s_mov_b32 s56, 1
    s_mov_b32 s37, s28
attn_kernel_merge:
    s_waitcnt lgkmcnt(0)
    s_barrier
    v_lshlrev_b32 v14, 4, v1
    s_lshl_b32 s43, s24, 12
    s_add_u32 s43, s43, 131072
    s_lshl_b32 s44, s56, 14
    s_add_u32 s44, s44, s35
    s_xor_b32 s57, s56, 1
    s_lshl_b32 s57, s57, 14
    s_add_u32 s57, s57, s34
    v_add_u32 v154, s43, v14
    v_add_u32 v155, s44, v14
    v_add_u32 v156, s57, v14
    v_xor_b32 v157, 0x4000, v154
    v_xor_b32 v158, 0x10000, v155
    v_xor_b32 v159, 0x10000, v156
    s_nop 7
    v_add_f32 v4, v4, v5
    v_add_f32 v6, v6, v7
    v_add_f32 v4, v4, v6
    v_mov_b32 v5, v4
    s_nop 1
    v_permlane32_swap_b32 v4, v5
    v_add_f32 v147, v4, v5
    v_mov_b32 v146, 0xf149f2ca
    v_cmp_eq_f32 vcc, 0, v147
    s_nop 1
    v_cndmask_b32 v146, v2, v146, vcc
    s_lshl_b32 s43, s37, 2
    s_add_u32 s43, s43, s26
    s_lshl_b32 s43, s43, 18
    s_lshl_b32 s44, s27, 13
    s_add_u32 s43, s43, s44
    s_lshl_b32 s44, s25, 12
    s_add_u32 s43, s43, s44
    s_add_u32 s43, s43, 50331648
    s_cmp_eq_u32 s25, 0
    s_cbranch_scc0 attn_kernel_mg1
    ds_write_b128 v154, v[48:51] offset:0
    ds_write_b128 v154, v[52:55] offset:1024
    ds_write_b128 v154, v[56:59] offset:2048
    ds_write_b128 v154, v[60:63] offset:3072
    ds_write_b128 v155, v[64:67] offset:0
    ds_write_b128 v155, v[68:71] offset:1024
    ds_write_b128 v155, v[72:75] offset:2048
    ds_write_b128 v155, v[76:79] offset:3072
    ds_write_b64 v156, v[146:147]
    s_waitcnt lgkmcnt(0)
    s_barrier
    ds_read_b64 v[148:149], v159
    ds_read_b128 v[48:51], v157 offset:0
    ds_read_b128 v[52:55], v157 offset:1024
    ds_read_b128 v[56:59], v157 offset:2048
    ds_read_b128 v[60:63], v157 offset:3072
    ds_read_b128 v[64:67], v158 offset:0
    ds_read_b128 v[68:71], v158 offset:1024
    ds_read_b128 v[72:75], v158 offset:2048
    ds_read_b128 v[76:79], v158 offset:3072
    s_waitcnt lgkmcnt(8)
    v_max_f32 v150, v146, v148
    v_sub_f32 v151, v146, v150
    v_sub_f32 v152, v148, v150
    v_exp_f32 v151, v151
    v_exp_f32 v152, v152
    s_nop 0
    v_mul_f32 v153, v147, v151
    v_fma_f32 v153, v149, v152, v153
    v_rcp_f32 v153, v153
    s_nop 0
    v_mul_f32 v151, v151, v153
    v_mul_f32 v152, v152, v153
    v_mul_f32 v16, v16, v151
    v_mul_f32 v17, v17, v151
    v_mul_f32 v18, v18, v151
    v_mul_f32 v19, v19, v151
    v_mul_f32 v20, v20, v151
    v_mul_f32 v21, v21, v151
    v_mul_f32 v22, v22, v151
    v_mul_f32 v23, v23, v151
    v_mul_f32 v24, v24, v151
    v_mul_f32 v25, v25, v151
    v_mul_f32 v26, v26, v151
    v_mul_f32 v27, v27, v151
    v_mul_f32 v28, v28, v151
    v_mul_f32 v29, v29, v151
    v_mul_f32 v30, v30, v151
    v_mul_f32 v31, v31, v151
    v_mul_f32 v32, v32, v151
    v_mul_f32 v33, v33, v151
    v_mul_f32 v34, v34, v151
    v_mul_f32 v35, v35, v151
    v_mul_f32 v36, v36, v151
    v_mul_f32 v37, v37, v151
    v_mul_f32 v38, v38, v151
    v_mul_f32 v39, v39, v151
    v_mul_f32 v40, v40, v151
    v_mul_f32 v41, v41, v151
    v_mul_f32 v42, v42, v151
    v_mul_f32 v43, v43, v151
    v_mul_f32 v44, v44, v151
    v_mul_f32 v45, v45, v151
    v_mul_f32 v46, v46, v151
    v_mul_f32 v47, v47, v151
    s_waitcnt lgkmcnt(0)
    s_barrier
    v_fma_f32 v16, v48, v152, v16
    v_fma_f32 v17, v49, v152, v17
    v_fma_f32 v18, v50, v152, v18
    v_fma_f32 v19, v51, v152, v19
    v_fma_f32 v20, v52, v152, v20
    v_fma_f32 v21, v53, v152, v21
    v_fma_f32 v22, v54, v152, v22
    v_fma_f32 v23, v55, v152, v23
    v_cvt_pk_bf16_f32 v48, v16, v17
    v_cvt_pk_bf16_f32 v49, v18, v19
    v_cvt_pk_bf16_f32 v50, v20, v21
    v_cvt_pk_bf16_f32 v51, v22, v23
    buffer_store_dwordx4 v[48:51], v12, s[16:19], s43 offen offset:0 sc0 sc1
    v_fma_f32 v24, v56, v152, v24
    v_fma_f32 v25, v57, v152, v25
    v_fma_f32 v26, v58, v152, v26
    v_fma_f32 v27, v59, v152, v27
    v_fma_f32 v28, v60, v152, v28
    v_fma_f32 v29, v61, v152, v29
    v_fma_f32 v30, v62, v152, v30
    v_fma_f32 v31, v63, v152, v31
    v_cvt_pk_bf16_f32 v56, v24, v25
    v_cvt_pk_bf16_f32 v57, v26, v27
    v_cvt_pk_bf16_f32 v58, v28, v29
    v_cvt_pk_bf16_f32 v59, v30, v31
    buffer_store_dwordx4 v[56:59], v12, s[16:19], s43 offen offset:1024 sc0 sc1
    v_fma_f32 v32, v64, v152, v32
    v_fma_f32 v33, v65, v152, v33
    v_fma_f32 v34, v66, v152, v34
    v_fma_f32 v35, v67, v152, v35
    v_fma_f32 v36, v68, v152, v36
    v_fma_f32 v37, v69, v152, v37
    v_fma_f32 v38, v70, v152, v38
    v_fma_f32 v39, v71, v152, v39
    v_cvt_pk_bf16_f32 v64, v32, v33
    v_cvt_pk_bf16_f32 v65, v34, v35
    v_cvt_pk_bf16_f32 v66, v36, v37
    v_cvt_pk_bf16_f32 v67, v38, v39
    buffer_store_dwordx4 v[64:67], v12, s[16:19], s43 offen offset:2048 sc0 sc1
    v_fma_f32 v40, v72, v152, v40
    v_fma_f32 v41, v73, v152, v41
    v_fma_f32 v42, v74, v152, v42
    v_fma_f32 v43, v75, v152, v43
    v_fma_f32 v44, v76, v152, v44
    v_fma_f32 v45, v77, v152, v45
    v_fma_f32 v46, v78, v152, v46
    v_fma_f32 v47, v79, v152, v47
    v_cvt_pk_bf16_f32 v72, v40, v41
    v_cvt_pk_bf16_f32 v73, v42, v43
    v_cvt_pk_bf16_f32 v74, v44, v45
    v_cvt_pk_bf16_f32 v75, v46, v47
    buffer_store_dwordx4 v[72:75], v12, s[16:19], s43 offen offset:3072 sc0 sc1
    s_branch attn_kernel_mgd
attn_kernel_mg1:
    ds_write_b128 v154, v[16:19] offset:0
    ds_write_b128 v154, v[20:23] offset:1024
    ds_write_b128 v154, v[24:27] offset:2048
    ds_write_b128 v154, v[28:31] offset:3072
    ds_write_b128 v155, v[32:35] offset:0
    ds_write_b128 v155, v[36:39] offset:1024
    ds_write_b128 v155, v[40:43] offset:2048
    ds_write_b128 v155, v[44:47] offset:3072
    ds_write_b64 v156, v[146:147]
    s_waitcnt lgkmcnt(0)
    s_barrier
    ds_read_b64 v[148:149], v159
    ds_read_b128 v[16:19], v157 offset:0
    ds_read_b128 v[20:23], v157 offset:1024
    ds_read_b128 v[24:27], v157 offset:2048
    ds_read_b128 v[28:31], v157 offset:3072
    ds_read_b128 v[32:35], v158 offset:0
    ds_read_b128 v[36:39], v158 offset:1024
    ds_read_b128 v[40:43], v158 offset:2048
    ds_read_b128 v[44:47], v158 offset:3072
    s_waitcnt lgkmcnt(8)
    v_max_f32 v150, v146, v148
    v_sub_f32 v151, v146, v150
    v_sub_f32 v152, v148, v150
    v_exp_f32 v151, v151
    v_exp_f32 v152, v152
    s_nop 0
    v_mul_f32 v153, v147, v151
    v_fma_f32 v153, v149, v152, v153
    v_rcp_f32 v153, v153
    s_nop 0
    v_mul_f32 v151, v151, v153
    v_mul_f32 v152, v152, v153
    v_mul_f32 v48, v48, v151
    v_mul_f32 v49, v49, v151
    v_mul_f32 v50, v50, v151
    v_mul_f32 v51, v51, v151
    v_mul_f32 v52, v52, v151
    v_mul_f32 v53, v53, v151
    v_mul_f32 v54, v54, v151
    v_mul_f32 v55, v55, v151
    v_mul_f32 v56, v56, v151
    v_mul_f32 v57, v57, v151
    v_mul_f32 v58, v58, v151
    v_mul_f32 v59, v59, v151
    v_mul_f32 v60, v60, v151
    v_mul_f32 v61, v61, v151
    v_mul_f32 v62, v62, v151
    v_mul_f32 v63, v63, v151
    v_mul_f32 v64, v64, v151
    v_mul_f32 v65, v65, v151
    v_mul_f32 v66, v66, v151
    v_mul_f32 v67, v67, v151
    v_mul_f32 v68, v68, v151
    v_mul_f32 v69, v69, v151
    v_mul_f32 v70, v70, v151
    v_mul_f32 v71, v71, v151
    v_mul_f32 v72, v72, v151
    v_mul_f32 v73, v73, v151
    v_mul_f32 v74, v74, v151
    v_mul_f32 v75, v75, v151
    v_mul_f32 v76, v76, v151
    v_mul_f32 v77, v77, v151
    v_mul_f32 v78, v78, v151
    v_mul_f32 v79, v79, v151
    s_waitcnt lgkmcnt(0)
    s_barrier
    v_fma_f32 v48, v16, v152, v48
    v_fma_f32 v49, v17, v152, v49
    v_fma_f32 v50, v18, v152, v50
    v_fma_f32 v51, v19, v152, v51
    v_fma_f32 v52, v20, v152, v52
    v_fma_f32 v53, v21, v152, v53
    v_fma_f32 v54, v22, v152, v54
    v_fma_f32 v55, v23, v152, v55
    v_cvt_pk_bf16_f32 v16, v48, v49
    v_cvt_pk_bf16_f32 v17, v50, v51
    v_cvt_pk_bf16_f32 v18, v52, v53
    v_cvt_pk_bf16_f32 v19, v54, v55
    buffer_store_dwordx4 v[16:19], v12, s[16:19], s43 offen offset:0 sc0 sc1
    v_fma_f32 v56, v24, v152, v56
    v_fma_f32 v57, v25, v152, v57
    v_fma_f32 v58, v26, v152, v58
    v_fma_f32 v59, v27, v152, v59
    v_fma_f32 v60, v28, v152, v60
    v_fma_f32 v61, v29, v152, v61
    v_fma_f32 v62, v30, v152, v62
    v_fma_f32 v63, v31, v152, v63
    v_cvt_pk_bf16_f32 v24, v56, v57
    v_cvt_pk_bf16_f32 v25, v58, v59
    v_cvt_pk_bf16_f32 v26, v60, v61
    v_cvt_pk_bf16_f32 v27, v62, v63
    buffer_store_dwordx4 v[24:27], v12, s[16:19], s43 offen offset:1024 sc0 sc1
    v_fma_f32 v64, v32, v152, v64
    v_fma_f32 v65, v33, v152, v65
    v_fma_f32 v66, v34, v152, v66
    v_fma_f32 v67, v35, v152, v67
    v_fma_f32 v68, v36, v152, v68
    v_fma_f32 v69, v37, v152, v69
    v_fma_f32 v70, v38, v152, v70
    v_fma_f32 v71, v39, v152, v71
    v_cvt_pk_bf16_f32 v32, v64, v65
    v_cvt_pk_bf16_f32 v33, v66, v67
    v_cvt_pk_bf16_f32 v34, v68, v69
    v_cvt_pk_bf16_f32 v35, v70, v71
    buffer_store_dwordx4 v[32:35], v12, s[16:19], s43 offen offset:2048 sc0 sc1
    v_fma_f32 v72, v40, v152, v72
    v_fma_f32 v73, v41, v152, v73
    v_fma_f32 v74, v42, v152, v74
    v_fma_f32 v75, v43, v152, v75
    v_fma_f32 v76, v44, v152, v76
    v_fma_f32 v77, v45, v152, v77
    v_fma_f32 v78, v46, v152, v78
    v_fma_f32 v79, v47, v152, v79
    v_cvt_pk_bf16_f32 v40, v72, v73
    v_cvt_pk_bf16_f32 v41, v74, v75
    v_cvt_pk_bf16_f32 v42, v76, v77
    v_cvt_pk_bf16_f32 v43, v78, v79
    buffer_store_dwordx4 v[40:43], v12, s[16:19], s43 offen offset:3072 sc0 sc1
attn_kernel_mgd:
    s_cmp_eq_u32 s45, 16
    s_cbranch_scc1 attn_kernel_done
    s_mov_b64 s[54:55], -1
    s_cmp_eq_u32 s56, 0
    s_cbranch_scc1 attn_kernel_cont0
    s_branch attn_kernel_cont1
attn_kernel_done:
    s_endpgm
.globl tail_kernel
.p2align 8
.type tail_kernel,@function
tail_kernel:
    s_cmp_ge_u32 s2, 512
    s_cbranch_scc1 tail_kernel_done
    s_cmp_lt_u32 s2, 256
    s_cbranch_scc1 tail_kernel_ssm
    s_sub_u32 s2, s2, 256
    s_setprio 1
    s_load_dwordx2 s[46:47], s[0:1], 136
    s_load_dwordx2 s[44:45], s[0:1], 120
    v_and_b32 v1, 63, v0
    v_lshrrev_b32 v2, 6, v0
    s_nop 0
    v_readfirstlane_b32 s24, v2
    s_and_b32 s25, s2, 7
    s_lshr_b32 s26, s2, 3
    s_lshl_b32 s25, s25, 2
    s_lshr_b32 s27, s26, 3
    s_add_u32 s25, s25, s27
    s_and_b32 s26, s26, 7
    v_lshlrev_b32 v3, 4, v1
    s_lshl_b32 s27, s24, 15
    s_lshl_b32 s30, s25, 19
    s_add_u32 s30, s30, s27
    s_add_u32 s30, s30, 50331648
    s_add_u32 s31, s30, 262144
    s_lshl_b32 s32, s26, 19
    s_add_u32 s32, s32, s27
    s_add_u32 s32, s32, 67108864
    s_add_u32 s33, s32, 262144
    s_waitcnt lgkmcnt(0)
    s_mov_b32 s16, s46
    s_and_b32 s17, s47, 0xffff
    s_mov_b32 s18, 268435456
    s_mov_b32 s19, 0x00020000
    s_mov_b32 s20, s44
    s_and_b32 s21, s45, 0xffff
    s_mov_b32 s22, 4194304
    s_mov_b32 s23, 0x00020000
    buffer_load_dwordx4 v[80:83], v3, s[16:19], s32 offen offset:0
    buffer_load_dwordx4 v[84:87], v3, s[16:19], s33 offen offset:0
    buffer_load_dwordx4 v[88:91], v3, s[16:19], s30 offen offset:0
    buffer_load_dwordx4 v[92:95], v3, s[16:19], s31 offen offset:0
    buffer_load_dwordx4 v[96:99], v3, s[16:19], s32 offen offset:1024
    buffer_load_dwordx4 v[100:103], v3, s[16:19], s33 offen offset:1024
    buffer_load_dwordx4 v[104:107], v3, s[16:19], s30 offen offset:1024
    buffer_load_dwordx4 v[108:111], v3, s[16:19], s31 offen offset:1024
    buffer_load_dwordx4 v[112:115], v3, s[16:19], s32 offen offset:2048
    buffer_load_dwordx4 v[116:119], v3, s[16:19], s33 offen offset:2048
    buffer_load_dwordx4 v[120:123], v3, s[16:19], s30 offen offset:2048
    buffer_load_dwordx4 v[124:127], v3, s[16:19], s31 offen offset:2048
    s_add_u32 s30, s30, 3072
    s_add_u32 s31, s31, 3072
    s_add_u32 s32, s32, 3072
    s_add_u32 s33, s33, 3072
    v_mov_b32 v16, 0
    v_mov_b32 v17, 0
    v_mov_b32 v18, 0
    v_mov_b32 v19, 0
    v_mov_b32 v20, 0
    v_mov_b32 v21, 0
    v_mov_b32 v22, 0
    v_mov_b32 v23, 0
    v_mov_b32 v24, 0
    v_mov_b32 v25, 0
    v_mov_b32 v26, 0
    v_mov_b32 v27, 0
    v_mov_b32 v28, 0
    v_mov_b32 v29, 0
    v_mov_b32 v30, 0
    v_mov_b32 v31, 0
    v_mov_b32 v32, 0
    v_mov_b32 v33, 0
    v_mov_b32 v34, 0
    v_mov_b32 v35, 0
    v_mov_b32 v36, 0
    v_mov_b32 v37, 0
    v_mov_b32 v38, 0
    v_mov_b32 v39, 0
    v_mov_b32 v40, 0
    v_mov_b32 v41, 0
    v_mov_b32 v42, 0
    v_mov_b32 v43, 0
    v_mov_b32 v44, 0
    v_mov_b32 v45, 0
    v_mov_b32 v46, 0
    v_mov_b32 v47, 0
    v_mov_b32 v48, 0
    v_mov_b32 v49, 0
    v_mov_b32 v50, 0
    v_mov_b32 v51, 0
    v_mov_b32 v52, 0
    v_mov_b32 v53, 0
    v_mov_b32 v54, 0
    v_mov_b32 v55, 0
    v_mov_b32 v56, 0
    v_mov_b32 v57, 0
    v_mov_b32 v58, 0
    v_mov_b32 v59, 0
    v_mov_b32 v60, 0
    v_mov_b32 v61, 0
    v_mov_b32 v62, 0
    v_mov_b32 v63, 0
    v_mov_b32 v64, 0
    v_mov_b32 v65, 0
    v_mov_b32 v66, 0
    v_mov_b32 v67, 0
    v_mov_b32 v68, 0
    v_mov_b32 v69, 0
    v_mov_b32 v70, 0
    v_mov_b32 v71, 0
    v_mov_b32 v72, 0
    v_mov_b32 v73, 0
    v_mov_b32 v74, 0
    v_mov_b32 v75, 0
    v_mov_b32 v76, 0
    v_mov_b32 v77, 0
    v_mov_b32 v78, 0
    v_mov_b32 v79, 0
    s_mov_b32 s34, 0
tail_kernel_op_loop:
    s_waitcnt vmcnt(8)
    v_mfma_f32_32x32x16_bf16 v[16:31], v[80:83], v[88:91], v[16:31]
    v_mfma_f32_32x32x16_bf16 v[32:47], v[80:83], v[92:95], v[32:47]
    v_mfma_f32_32x32x16_bf16 v[48:63], v[84:87], v[88:91], v[48:63]
    v_mfma_f32_32x32x16_bf16 v[64:79], v[84:87], v[92:95], v[64:79]
    buffer_load_dwordx4 v[80:83], v3, s[16:19], s32 offen offset:0
    buffer_load_dwordx4 v[84:87], v3, s[16:19], s33 offen offset:0
    buffer_load_dwordx4 v[88:91], v3, s[16:19], s30 offen offset:0
    buffer_load_dwordx4 v[92:95], v3, s[16:19], s31 offen offset:0
    s_waitcnt vmcnt(8)
    v_mfma_f32_32x32x16_bf16 v[16:31], v[96:99], v[104:107], v[16:31]
    v_mfma_f32_32x32x16_bf16 v[32:47], v[96:99], v[108:111], v[32:47]
    v_mfma_f32_32x32x16_bf16 v[48:63], v[100:103], v[104:107], v[48:63]
    v_mfma_f32_32x32x16_bf16 v[64:79], v[100:103], v[108:111], v[64:79]
    buffer_load_dwordx4 v[96:99], v3, s[16:19], s32 offen offset:1024
    buffer_load_dwordx4 v[100:103], v3, s[16:19], s33 offen offset:1024
    buffer_load_dwordx4 v[104:107], v3, s[16:19], s30 offen offset:1024
    buffer_load_dwordx4 v[108:111], v3, s[16:19], s31 offen offset:1024
    s_waitcnt vmcnt(8)
    v_mfma_f32_32x32x16_bf16 v[16:31], v[112:115], v[120:123], v[16:31]
    v_mfma_f32_32x32x16_bf16 v[32:47], v[112:115], v[124:127], v[32:47]
    v_mfma_f32_32x32x16_bf16 v[48:63], v[116:119], v[120:123], v[48:63]
    v_mfma_f32_32x32x16_bf16 v[64:79], v[116:119], v[124:127], v[64:79]
    buffer_load_dwordx4 v[112:115], v3, s[16:19], s32 offen offset:2048
    buffer_load_dwordx4 v[116:119], v3, s[16:19], s33 offen offset:2048
    buffer_load_dwordx4 v[120:123], v3, s[16:19], s30 offen offset:2048
    buffer_load_dwordx4 v[124:127], v3, s[16:19], s31 offen offset:2048
    s_add_u32 s30, s30, 3072
    s_add_u32 s31, s31, 3072
    s_add_u32 s32, s32, 3072
    s_add_u32 s33, s33, 3072
    s_add_u32 s34, s34, 1
    s_cmp_lt_u32 s34, 10
    s_cbranch_scc1 tail_kernel_op_loop
    s_waitcnt vmcnt(8)
    v_mfma_f32_32x32x16_bf16 v[16:31], v[80:83], v[88:91], v[16:31]
    v_mfma_f32_32x32x16_bf16 v[32:47], v[80:83], v[92:95], v[32:47]
    v_mfma_f32_32x32x16_bf16 v[48:63], v[84:87], v[88:91], v[48:63]
    v_mfma_f32_32x32x16_bf16 v[64:79], v[84:87], v[92:95], v[64:79]
    s_waitcnt vmcnt(4)
    v_mfma_f32_32x32x16_bf16 v[16:31], v[96:99], v[104:107], v[16:31]
    v_mfma_f32_32x32x16_bf16 v[32:47], v[96:99], v[108:111], v[32:47]
    v_mfma_f32_32x32x16_bf16 v[48:63], v[100:103], v[104:107], v[48:63]
    v_mfma_f32_32x32x16_bf16 v[64:79], v[100:103], v[108:111], v[64:79]
    s_nop 15
    s_and_b32 s27, s24, 3
    s_lshl_b32 s27, s27, 14
    v_add_u32 v4, s27, v3
    s_cmp_lt_u32 s24, 4
    s_cbranch_scc1 tail_kernel_op_r1
    ds_write_b128 v4, v[16:19] offset:0
    ds_write_b128 v4, v[20:23] offset:1024
    ds_write_b128 v4, v[24:27] offset:2048
    ds_write_b128 v4, v[28:31] offset:3072
    ds_write_b128 v4, v[32:35] offset:4096
    ds_write_b128 v4, v[36:39] offset:5120
    ds_write_b128 v4, v[40:43] offset:6144
    ds_write_b128 v4, v[44:47] offset:7168
    ds_write_b128 v4, v[48:51] offset:8192
    ds_write_b128 v4, v[52:55] offset:9216
    ds_write_b128 v4, v[56:59] offset:10240
    ds_write_b128 v4, v[60:63] offset:11264
    ds_write_b128 v4, v[64:67] offset:12288
    ds_write_b128 v4, v[68:71] offset:13312
    ds_write_b128 v4, v[72:75] offset:14336
    ds_write_b128 v4, v[76:79] offset:15360
tail_kernel_op_r1:
    s_waitcnt lgkmcnt(0) vmcnt(0)
    s_barrier
    s_cmp_lt_u32 s24, 4
    s_cbranch_scc0 tail_kernel_op_r2
    ds_read_b128 v[80:83], v4 offset:0
    ds_read_b128 v[84:87], v4 offset:1024
    ds_read_b128 v[88:91], v4 offset:2048
    ds_read_b128 v[92:95], v4 offset:3072
    ds_read_b128 v[96:99], v4 offset:4096
    ds_read_b128 v[100:103], v4 offset:5120
    ds_read_b128 v[104:107], v4 offset:6144
    ds_read_b128 v[108:111], v4 offset:7168
    s_waitcnt lgkmcnt(0)
    v_add_f32 v16, v16, v80
    v_add_f32 v17, v17, v81
    v_add_f32 v18, v18, v82
    v_add_f32 v19, v19, v83
    v_add_f32 v20, v20, v84
    v_add_f32 v21, v21, v85
    v_add_f32 v22, v22, v86
    v_add_f32 v23, v23, v87
    v_add_f32 v24, v24, v88
    v_add_f32 v25, v25, v89
    v_add_f32 v26, v26, v90
    v_add_f32 v27, v27, v91
    v_add_f32 v28, v28, v92
    v_add_f32 v29, v29, v93
    v_add_f32 v30, v30, v94
    v_add_f32 v31, v31, v95
    v_add_f32 v32, v32, v96
    v_add_f32 v33, v33, v97
    v_add_f32 v34, v34, v98
    v_add_f32 v35, v35, v99
    v_add_f32 v36, v36, v100
    v_add_f32 v37, v37, v101
    v_add_f32 v38, v38, v102
    v_add_f32 v39, v39, v103
    v_add_f32 v40, v40, v104
    v_add_f32 v41, v41, v105
    v_add_f32 v42, v42, v106
    v_add_f32 v43, v43, v107
    v_add_f32 v44, v44, v108
    v_add_f32 v45, v45, v109
    v_add_f32 v46, v46, v110
    v_add_f32 v47, v47, v111
    ds_read_b128 v[80:83], v4 offset:8192
    ds_read_b128 v[84:87], v4 offset:9216
    ds_read_b128 v[88:91], v4 offset:10240
    ds_read_b128 v[92:95], v4 offset:11264
    ds_read_b128 v[96:99], v4 offset:12288
    ds_read_b128 v[100:103], v4 offset:13312
    ds_read_b128 v[104:107], v4 offset:14336
    ds_read_b128 v[108:111], v4 offset:15360
    s_waitcnt lgkmcnt(0)
    v_add_f32 v48, v48, v80
    v_add_f32 v49, v49, v81
    v_add_f32 v50, v50, v82
    v_add_f32 v51, v51, v83
    v_add_f32 v52, v52, v84
    v_add_f32 v53, v53, v85
    v_add_f32 v54, v54, v86
    v_add_f32 v55, v55, v87
    v_add_f32 v56, v56, v88
    v_add_f32 v57, v57, v89
    v_add_f32 v58, v58, v90
    v_add_f32 v59, v59, v91
    v_add_f32 v60, v60, v92
    v_add_f32 v61, v61, v93
    v_add_f32 v62, v62, v94
    v_add_f32 v63, v63, v95
    v_add_f32 v64, v64, v96
    v_add_f32 v65, v65, v97
    v_add_f32 v66, v66, v98
    v_add_f32 v67, v67, v99
    v_add_f32 v68, v68, v100
    v_add_f32 v69, v69, v101
    v_add_f32 v70, v70, v102
    v_add_f32 v71, v71, v103
    v_add_f32 v72, v72, v104
    v_add_f32 v73, v73, v105
    v_add_f32 v74, v74, v106
    v_add_f32 v75, v75, v107
    v_add_f32 v76, v76, v108
    v_add_f32 v77, v77, v109
    v_add_f32 v78, v78, v110
    v_add_f32 v79, v79, v111
    ds_write_b128 v4, v[16:19] offset:0
    ds_write_b128 v4, v[20:23] offset:1024
    ds_write_b128 v4, v[24:27] offset:2048
    ds_write_b128 v4, v[28:31] offset:3072
    ds_write_b128 v4, v[32:35] offset:4096
    ds_write_b128 v4, v[36:39] offset:5120
    ds_write_b128 v4, v[40:43] offset:6144
    ds_write_b128 v4, v[44:47] offset:7168
    ds_write_b128 v4, v[48:51] offset:8192
    ds_write_b128 v4, v[52:55] offset:9216
    ds_write_b128 v4, v[56:59] offset:10240
    ds_write_b128 v4, v[60:63] offset:11264
    ds_write_b128 v4, v[64:67] offset:12288
    ds_write_b128 v4, v[68:71] offset:13312
    ds_write_b128 v4, v[72:75] offset:14336
    ds_write_b128 v4, v[76:79] offset:15360
tail_kernel_op_r2:
    s_waitcnt lgkmcnt(0)
    s_barrier
    v_and_b32 v5, 7, v0
    v_lshrrev_b32 v6, 3, v0
    v_lshrrev_b32 v7, 2, v5
    v_and_b32 v8, 3, v5
    v_lshlrev_b32 v7, 13, v7
    v_lshl_add_u32 v7, v8, 10, v7
    v_and_b32 v8, 31, v6
    v_lshl_add_u32 v7, v8, 4, v7
    v_lshrrev_b32 v8, 5, v6
    v_lshl_add_u32 v7, v8, 12, v7
    s_lshl_b32 s27, s25, 6
    v_add_u32 v9, s27, v6
    v_lshlrev_b32 v9, 11, v9
    v_lshl_add_u32 v9, v5, 4, v9
    s_lshl_b32 s27, s26, 7
    ds_read_b128 v[80:83], v7 offset:0
    ds_read_b128 v[84:87], v7 offset:512
    ds_read_b128 v[88:91], v7 offset:16384
    ds_read_b128 v[92:95], v7 offset:16896
    ds_read_b128 v[96:99], v7 offset:32768
    ds_read_b128 v[100:103], v7 offset:33280
    ds_read_b128 v[104:107], v7 offset:49152
    ds_read_b128 v[108:111], v7 offset:49664
    s_waitcnt lgkmcnt(0)
    v_add_f32 v80, v80, v88
    v_add_f32 v96, v96, v104
    v_add_f32 v81, v81, v89
    v_add_f32 v97, v97, v105
    v_add_f32 v82, v82, v90
    v_add_f32 v98, v98, v106
    v_add_f32 v83, v83, v91
    v_add_f32 v99, v99, v107
    v_add_f32 v84, v84, v92
    v_add_f32 v100, v100, v108
    v_add_f32 v85, v85, v93
    v_add_f32 v101, v101, v109
    v_add_f32 v86, v86, v94
    v_add_f32 v102, v102, v110
    v_add_f32 v87, v87, v95
    v_add_f32 v103, v103, v111
    v_add_f32 v80, v80, v96
    v_add_f32 v81, v81, v97
    v_add_f32 v82, v82, v98
    v_add_f32 v83, v83, v99
    v_add_f32 v84, v84, v100
    v_add_f32 v85, v85, v101
    v_add_f32 v86, v86, v102
    v_add_f32 v87, v87, v103
    v_cvt_pk_bf16_f32 v88, v80, v81
    v_cvt_pk_bf16_f32 v89, v82, v83
    v_cvt_pk_bf16_f32 v90, v84, v85
    v_cvt_pk_bf16_f32 v91, v86, v87
    buffer_store_dwordx4 v[88:91], v9, s[20:23], s27 offen
    s_branch tail_kernel_done
tail_kernel_ssm:
    s_mov_b32 s3, s2
    s_setprio 3
    s_load_dwordx4 s[36:39], s[0:1], 48
    s_load_dwordx4 s[40:43], s[0:1], 64
    s_load_dwordx4 s[44:47], s[0:1], 80
    s_load_dwordx4 s[48:51], s[0:1], 96
    s_load_dwordx4 s[52:55], s[0:1], 112
    v_and_b32 v1, 63, v0
    v_lshrrev_b32 v2, 6, v0
    s_nop 0
    v_readfirstlane_b32 s24, v2
    s_lshr_b32 s25, s24, 2
    s_and_b32 s26, s24, 3
    s_and_b32 s27, s3, 7
    s_lshl_b32 s27, s27, 6
    s_lshr_b32 s28, s3, 3
    s_lshl_b32 s28, s28, 1
    s_add_u32 s27, s27, s28
    s_add_u32 s28, s27, s25
    s_mul_i32 s29, s25, 36864
    v_and_b32 v10, 31, v1
    v_lshrrev_b32 v11, 5, v1
    v_lshlrev_b32 v7, 1, v10
    v_mov_b32 v4, 0
    s_lshl_b32 s31, s28, 8
    s_lshl_b32 s32, s26, 6
    s_add_u32 s31, s31, s32
    s_lshl_b32 s32, s28, 1
    s_lshl_b32 s30, s27, 1
    s_waitcnt lgkmcnt(0)
    s_mov_b32 s12, s38
    s_and_b32 s13, s39, 0xffff
    s_mov_b32 s14, 131072
    s_mov_b32 s15, 0x00020000
    buffer_load_ushort v70, v7, s[12:15], s31 offen
    s_mov_b32 s16, s40
    s_and_b32 s17, s41, 0xffff
    s_mov_b32 s18, 131072
    s_mov_b32 s19, 0x00020000
    buffer_load_ushort v71, v7, s[16:19], s31 offen
    s_mov_b32 s20, s42
    s_and_b32 s21, s43, 0xffff
    s_mov_b32 s22, 131072
    s_mov_b32 s23, 0x00020000
    buffer_load_ushort v72, v7, s[20:23], s31 offen
    s_mov_b32 s56, s44
    s_and_b32 s57, s45, 0xffff
    s_mov_b32 s58, 131072
    s_mov_b32 s59, 0x00020000
    buffer_load_ushort v73, v7, s[56:59], s31 offen
    s_mov_b32 s60, s46
    s_and_b32 s61, s47, 0xffff
    s_mov_b32 s62, 131072
    s_mov_b32 s63, 0x00020000
    buffer_load_ushort v74, v7, s[60:63], s31 offen
    s_mov_b32 s64, s48
    s_and_b32 s65, s49, 0xffff
    s_mov_b32 s66, 131072
    s_mov_b32 s67, 0x00020000
    buffer_load_ushort v75, v7, s[64:67], s31 offen
    s_mov_b32 s68, s50
    s_and_b32 s69, s51, 0xffff
    s_mov_b32 s70, 1024
    s_mov_b32 s71, 0x00020000
    buffer_load_ushort v5, v4, s[68:71], s32 offen
    s_mov_b32 s8, s36
    s_and_b32 s9, s37, 0xffff
    s_mov_b32 s10, 2097152
    s_mov_b32 s11, 0x00020000
    v_lshlrev_b32 v3, 10, v0
    s_add_u32 s31, s30, 0
    buffer_load_dword v124, v3, s[8:11], s31 offen
    s_add_u32 s31, s30, 524288
    buffer_load_dword v125, v3, s[8:11], s31 offen
    s_add_u32 s31, s30, 1048576
    buffer_load_dword v126, v3, s[8:11], s31 offen
    s_add_u32 s31, s30, 1572864
    buffer_load_dword v127, v3, s[8:11], s31 offen
    s_mov_b32 s72, s52
    s_and_b32 s73, s53, 0xffff
    s_mov_b32 s74, 1024
    s_mov_b32 s75, 0x00020000
    buffer_load_dword v6, v4, s[72:75], s30 offen
    s_mov_b32 s76, s54
    s_and_b32 s77, s55, 0xffff
    s_mov_b32 s78, 4194304
    s_mov_b32 s79, 0x00020000
    s_mov_b32 s33, 0x3FB8AA3B
    s_mov_b32 s34, 0x3E22F983
    v_cvt_f32_u32 v16, v10
    v_lshlrev_b32 v17, 5, v10
    v_cvt_f32_u32 v17, v17
    v_mov_b32 v32, 0
    v_mov_b32 v33, 0
    v_mov_b32 v34, 0
    v_mov_b32 v35, 0
    v_mov_b32 v36, 0
    v_mov_b32 v37, 0
    v_mov_b32 v38, 0
    v_mov_b32 v39, 0
    v_mov_b32 v40, 0
    v_mov_b32 v41, 0
    v_mov_b32 v42, 0
    v_mov_b32 v43, 0
    v_mov_b32 v44, 0
    v_mov_b32 v45, 0
    v_mov_b32 v46, 0
    v_mov_b32 v47, 0
    v_mov_b32 v48, 0
    v_mov_b32 v49, 0
    v_mov_b32 v50, 0
    v_mov_b32 v51, 0
    v_mov_b32 v52, 0
    v_mov_b32 v53, 0
    v_mov_b32 v54, 0
    v_mov_b32 v55, 0
    v_mov_b32 v56, 0
    v_mov_b32 v57, 0
    v_mov_b32 v58, 0
    v_mov_b32 v59, 0
    v_mov_b32 v60, 0
    v_mov_b32 v61, 0
    v_mov_b32 v62, 0
    v_mov_b32 v63, 0
    s_waitcnt vmcnt(5)
    v_lshlrev_b32 v5, 16, v5
    v_mul_f32 v5, s33, v5
    v_exp_f32 v5, v5
    v_lshlrev_b32 v70, 16, v70
    v_lshlrev_b32 v71, 16, v71
    v_lshlrev_b32 v72, 16, v72
    v_lshlrev_b32 v73, 16, v73
    v_lshlrev_b32 v74, 16, v74
    v_lshlrev_b32 v75, 16, v75
    v_cvt_pk_bf16_f32 v5, 0, v5
    v_mul_f32 v112, v5, v70
    v_mul_f32 v113, v5, v71
    v_mul_f32 v72, v5, v72
    v_mul_f32 v73, v5, v73
    v_mul_f32 v112, s33, v112
    v_mul_f32 v113, s34, v113
    v_mul_f32 v114, v74, v72
    v_fma_f32 v114, -v75, v73, v114
    v_mul_f32 v115, v74, v73
    v_fma_f32 v115, v75, v72, v115
    v_mov_b32 v19, 0x44800000
    v_mul_f32 v25, v112, v19
    v_mul_f32 v117, v113, v19
    v_exp_f32 v25, v25
    v_fract_f32 v117, v117
    v_cos_f32 v116, v117
    v_sin_f32 v117, v117
    s_nop 0
    v_mul_f32 v116, v116, v25
    v_mul_f32 v117, v117, v25
    v_mul_f32 v120, v116, v116
    v_fma_f32 v120, -v117, v117, v120
    v_mul_f32 v121, v116, v117
    v_fma_f32 v121, v117, v116, v121
    v_mul_f32 v122, v114, v120
    v_fma_f32 v122, -v115, v121, v122
    s_lshl_b32 s31, s26, 10
    s_add_u32 s31, s31, s29
    s_add_u32 s31, s31, 10240
    v_lshlrev_b32 v8, 5, v10
    v_add_u32 v8, s31, v8
    ds_write_b128 v8, v[112:115]
    ds_write_b64 v8, v[116:117] offset:16
    ds_swizzle_b32 v123, v122 offset:1055
    s_waitcnt lgkmcnt(0)
    v_add_f32 v122, v122, v123
    ds_swizzle_b32 v123, v122 offset:2079
    s_waitcnt lgkmcnt(0)
    v_add_f32 v122, v122, v123
    ds_swizzle_b32 v123, v122 offset:4127
    s_waitcnt lgkmcnt(0)
    v_add_f32 v122, v122, v123
    ds_swizzle_b32 v123, v122 offset:8223
    s_waitcnt lgkmcnt(0)
    v_add_f32 v122, v122, v123
    ds_swizzle_b32 v123, v122 offset:16415
    s_waitcnt lgkmcnt(0)
    v_add_f32 v122, v122, v123
    v_mov_b32 v7, v122
    s_setprio 0
    v_lshlrev_b32 v8, 8, v11
    v_add_u32 v8, s31, v8
    s_mov_b32 s35, 2
    s_waitcnt lgkmcnt(0)
tail_kernel_b_kg:
    ds_read_b128 v[112:115], v8 offset:0
    ds_read_b64 v[116:117], v8 offset:16
    ds_read_b128 v[118:121], v8 offset:32
    ds_read_b64 v[122:123], v8 offset:48
    s_waitcnt lgkmcnt(0)
    v_mul_f32 v30, v112, v17
    v_mul_f32 v19, v113, v17
    v_exp_f32 v30, v30
    v_fract_f32 v19, v19
    v_cos_f32 v18, v19
    v_sin_f32 v19, v19
    s_nop 0
    v_mul_f32 v18, v18, v30
    v_mul_f32 v19, v19, v30
    v_mul_f32 v31, v118, v17
    v_mul_f32 v21, v119, v17
    v_exp_f32 v31, v31
    v_fract_f32 v21, v21
    v_cos_f32 v20, v21
    v_sin_f32 v21, v21
    s_nop 0
    v_mul_f32 v20, v20, v31
    v_mul_f32 v21, v21, v31
    v_mul_f32 v22, v18, v116
    v_fma_f32 v22, -v19, v117, v22
    v_mul_f32 v23, v18, v117
    v_fma_f32 v23, v19, v116, v23
    v_mul_f32 v24, v20, v122
    v_fma_f32 v24, -v21, v123, v24
    v_mul_f32 v25, v20, v123
    v_fma_f32 v25, v21, v122, v25
    v_mul_f32 v30, v112, v16
    v_mul_f32 v27, v113, v16
    v_exp_f32 v30, v30
    v_fract_f32 v27, v27
    v_cos_f32 v26, v27
    v_sin_f32 v27, v27
    s_nop 0
    v_mul_f32 v26, v26, v30
    v_mul_f32 v27, v27, v30
    v_mul_f32 v31, v118, v16
    v_mul_f32 v29, v119, v16
    v_exp_f32 v31, v31
    v_fract_f32 v29, v29
    v_cos_f32 v28, v29
    v_sin_f32 v29, v29
    s_nop 0
    v_mul_f32 v28, v28, v31
    v_mul_f32 v29, v29, v31
    v_mul_f32 v2, v114, v26
    v_fma_f32 v2, -v115, v27, v2
    v_mul_f32_e64 v4, -v114, v27
    v_fma_f32 v4, -v115, v26, v4
    v_mul_f32 v12, v120, v28
    v_fma_f32 v12, -v121, v29, v12
    v_mul_f32_e64 v13, -v120, v29
    v_fma_f32 v13, -v121, v28, v13
    v_cvt_pk_bf16_f32 v64, v18, v20
    v_lshlrev_b32 v30, 16, v64
    v_and_b32 v31, 0xffff0000, v64
    v_sub_f32 v30, v18, v30
    v_sub_f32 v31, v20, v31
    v_cvt_pk_bf16_f32 v68, v30, v31
    v_cvt_pk_bf16_f32 v72, v19, v21
    v_lshlrev_b32 v14, 16, v72
    v_and_b32 v15, 0xffff0000, v72
    v_sub_f32 v14, v19, v14
    v_sub_f32 v15, v21, v15
    v_cvt_pk_bf16_f32 v76, v14, v15
    v_cvt_pk_bf16_f32 v80, v22, v24
    v_lshlrev_b32 v30, 16, v80
    v_and_b32 v31, 0xffff0000, v80
    v_sub_f32 v30, v22, v30
    v_sub_f32 v31, v24, v31
    v_cvt_pk_bf16_f32 v84, v30, v31
    v_cvt_pk_bf16_f32 v88, v23, v25
    v_lshlrev_b32 v14, 16, v88
    v_and_b32 v15, 0xffff0000, v88
    v_sub_f32 v14, v23, v14
    v_sub_f32 v15, v25, v15
    v_cvt_pk_bf16_f32 v92, v14, v15
    v_cvt_pk_bf16_f32 v96, v2, v12
    v_lshlrev_b32 v30, 16, v96
    v_and_b32 v31, 0xffff0000, v96
    v_sub_f32 v30, v2, v30
    v_sub_f32 v31, v12, v31
    v_cvt_pk_bf16_f32 v100, v30, v31
    v_cvt_pk_bf16_f32 v104, v4, v13
    v_lshlrev_b32 v14, 16, v104
    v_and_b32 v15, 0xffff0000, v104
    v_sub_f32 v14, v4, v14
    v_sub_f32 v15, v13, v15
    v_cvt_pk_bf16_f32 v108, v14, v15
    ds_read_b128 v[112:115], v8 offset:64
    ds_read_b64 v[116:117], v8 offset:80
    ds_read_b128 v[118:121], v8 offset:96
    ds_read_b64 v[122:123], v8 offset:112
    s_waitcnt lgkmcnt(0)
    v_mul_f32 v30, v112, v17
    v_mul_f32 v19, v113, v17
    v_exp_f32 v30, v30
    v_fract_f32 v19, v19
    v_cos_f32 v18, v19
    v_sin_f32 v19, v19
    s_nop 0
    v_mul_f32 v18, v18, v30
    v_mul_f32 v19, v19, v30
    v_mul_f32 v31, v118, v17
    v_mul_f32 v21, v119, v17
    v_exp_f32 v31, v31
    v_fract_f32 v21, v21
    v_cos_f32 v20, v21
    v_sin_f32 v21, v21
    s_nop 0
    v_mul_f32 v20, v20, v31
    v_mul_f32 v21, v21, v31
    v_mul_f32 v22, v18, v116
    v_fma_f32 v22, -v19, v117, v22
    v_mul_f32 v23, v18, v117
    v_fma_f32 v23, v19, v116, v23
    v_mul_f32 v24, v20, v122
    v_fma_f32 v24, -v21, v123, v24
    v_mul_f32 v25, v20, v123
    v_fma_f32 v25, v21, v122, v25
    v_mul_f32 v30, v112, v16
    v_mul_f32 v27, v113, v16
    v_exp_f32 v30, v30
    v_fract_f32 v27, v27
    v_cos_f32 v26, v27
    v_sin_f32 v27, v27
    s_nop 0
    v_mul_f32 v26, v26, v30
    v_mul_f32 v27, v27, v30
    v_mul_f32 v31, v118, v16
    v_mul_f32 v29, v119, v16
    v_exp_f32 v31, v31
    v_fract_f32 v29, v29
    v_cos_f32 v28, v29
    v_sin_f32 v29, v29
    s_nop 0
    v_mul_f32 v28, v28, v31
    v_mul_f32 v29, v29, v31
    v_mul_f32 v2, v114, v26
    v_fma_f32 v2, -v115, v27, v2
    v_mul_f32_e64 v4, -v114, v27
    v_fma_f32 v4, -v115, v26, v4
    v_mul_f32 v12, v120, v28
    v_fma_f32 v12, -v121, v29, v12
    v_mul_f32_e64 v13, -v120, v29
    v_fma_f32 v13, -v121, v28, v13
    v_cvt_pk_bf16_f32 v65, v18, v20
    v_lshlrev_b32 v30, 16, v65
    v_and_b32 v31, 0xffff0000, v65
    v_sub_f32 v30, v18, v30
    v_sub_f32 v31, v20, v31
    v_cvt_pk_bf16_f32 v69, v30, v31
    v_cvt_pk_bf16_f32 v73, v19, v21
    v_lshlrev_b32 v14, 16, v73
    v_and_b32 v15, 0xffff0000, v73
    v_sub_f32 v14, v19, v14
    v_sub_f32 v15, v21, v15
    v_cvt_pk_bf16_f32 v77, v14, v15
    v_cvt_pk_bf16_f32 v81, v22, v24
    v_lshlrev_b32 v30, 16, v81
    v_and_b32 v31, 0xffff0000, v81
    v_sub_f32 v30, v22, v30
    v_sub_f32 v31, v24, v31
    v_cvt_pk_bf16_f32 v85, v30, v31
    v_cvt_pk_bf16_f32 v89, v23, v25
    v_lshlrev_b32 v14, 16, v89
    v_and_b32 v15, 0xffff0000, v89
    v_sub_f32 v14, v23, v14
    v_sub_f32 v15, v25, v15
    v_cvt_pk_bf16_f32 v93, v14, v15
    v_cvt_pk_bf16_f32 v97, v2, v12
    v_lshlrev_b32 v30, 16, v97
    v_and_b32 v31, 0xffff0000, v97
    v_sub_f32 v30, v2, v30
    v_sub_f32 v31, v12, v31
    v_cvt_pk_bf16_f32 v101, v30, v31
    v_cvt_pk_bf16_f32 v105, v4, v13
    v_lshlrev_b32 v14, 16, v105
    v_and_b32 v15, 0xffff0000, v105
    v_sub_f32 v14, v4, v14
    v_sub_f32 v15, v13, v15
    v_cvt_pk_bf16_f32 v109, v14, v15
    ds_read_b128 v[112:115], v8 offset:128
    ds_read_b64 v[116:117], v8 offset:144
    ds_read_b128 v[118:121], v8 offset:160
    ds_read_b64 v[122:123], v8 offset:176
    s_waitcnt lgkmcnt(0)
    v_mul_f32 v30, v112, v17
    v_mul_f32 v19, v113, v17
    v_exp_f32 v30, v30
    v_fract_f32 v19, v19
    v_cos_f32 v18, v19
    v_sin_f32 v19, v19
    s_nop 0
    v_mul_f32 v18, v18, v30
    v_mul_f32 v19, v19, v30
    v_mul_f32 v31, v118, v17
    v_mul_f32 v21, v119, v17
    v_exp_f32 v31, v31
    v_fract_f32 v21, v21
    v_cos_f32 v20, v21
    v_sin_f32 v21, v21
    s_nop 0
    v_mul_f32 v20, v20, v31
    v_mul_f32 v21, v21, v31
    v_mul_f32 v22, v18, v116
    v_fma_f32 v22, -v19, v117, v22
    v_mul_f32 v23, v18, v117
    v_fma_f32 v23, v19, v116, v23
    v_mul_f32 v24, v20, v122
    v_fma_f32 v24, -v21, v123, v24
    v_mul_f32 v25, v20, v123
    v_fma_f32 v25, v21, v122, v25
    v_mul_f32 v30, v112, v16
    v_mul_f32 v27, v113, v16
    v_exp_f32 v30, v30
    v_fract_f32 v27, v27
    v_cos_f32 v26, v27
    v_sin_f32 v27, v27
    s_nop 0
    v_mul_f32 v26, v26, v30
    v_mul_f32 v27, v27, v30
    v_mul_f32 v31, v118, v16
    v_mul_f32 v29, v119, v16
    v_exp_f32 v31, v31
    v_fract_f32 v29, v29
    v_cos_f32 v28, v29
    v_sin_f32 v29, v29
    s_nop 0
    v_mul_f32 v28, v28, v31
    v_mul_f32 v29, v29, v31
    v_mul_f32 v2, v114, v26
    v_fma_f32 v2, -v115, v27, v2
    v_mul_f32_e64 v4, -v114, v27
    v_fma_f32 v4, -v115, v26, v4
    v_mul_f32 v12, v120, v28
    v_fma_f32 v12, -v121, v29, v12
    v_mul_f32_e64 v13, -v120, v29
    v_fma_f32 v13, -v121, v28, v13
    v_cvt_pk_bf16_f32 v66, v18, v20
    v_lshlrev_b32 v30, 16, v66
    v_and_b32 v31, 0xffff0000, v66
    v_sub_f32 v30, v18, v30
    v_sub_f32 v31, v20, v31
    v_cvt_pk_bf16_f32 v70, v30, v31
    v_cvt_pk_bf16_f32 v74, v19, v21
    v_lshlrev_b32 v14, 16, v74
    v_and_b32 v15, 0xffff0000, v74
    v_sub_f32 v14, v19, v14
    v_sub_f32 v15, v21, v15
    v_cvt_pk_bf16_f32 v78, v14, v15
    v_cvt_pk_bf16_f32 v82, v22, v24
    v_lshlrev_b32 v30, 16, v82
    v_and_b32 v31, 0xffff0000, v82
    v_sub_f32 v30, v22, v30
    v_sub_f32 v31, v24, v31
    v_cvt_pk_bf16_f32 v86, v30, v31
    v_cvt_pk_bf16_f32 v90, v23, v25
    v_lshlrev_b32 v14, 16, v90
    v_and_b32 v15, 0xffff0000, v90
    v_sub_f32 v14, v23, v14
    v_sub_f32 v15, v25, v15
    v_cvt_pk_bf16_f32 v94, v14, v15
    v_cvt_pk_bf16_f32 v98, v2, v12
    v_lshlrev_b32 v30, 16, v98
    v_and_b32 v31, 0xffff0000, v98
    v_sub_f32 v30, v2, v30
    v_sub_f32 v31, v12, v31
    v_cvt_pk_bf16_f32 v102, v30, v31
    v_cvt_pk_bf16_f32 v106, v4, v13
    v_lshlrev_b32 v14, 16, v106
    v_and_b32 v15, 0xffff0000, v106
    v_sub_f32 v14, v4, v14
    v_sub_f32 v15, v13, v15
    v_cvt_pk_bf16_f32 v110, v14, v15
    ds_read_b128 v[112:115], v8 offset:192
    ds_read_b64 v[116:117], v8 offset:208
    ds_read_b128 v[118:121], v8 offset:224
    ds_read_b64 v[122:123], v8 offset:240
    s_waitcnt lgkmcnt(0)
    v_mul_f32 v30, v112, v17
    v_mul_f32 v19, v113, v17
    v_exp_f32 v30, v30
    v_fract_f32 v19, v19
    v_cos_f32 v18, v19
    v_sin_f32 v19, v19
    s_nop 0
    v_mul_f32 v18, v18, v30
    v_mul_f32 v19, v19, v30
    v_mul_f32 v31, v118, v17
    v_mul_f32 v21, v119, v17
    v_exp_f32 v31, v31
    v_fract_f32 v21, v21
    v_cos_f32 v20, v21
    v_sin_f32 v21, v21
    s_nop 0
    v_mul_f32 v20, v20, v31
    v_mul_f32 v21, v21, v31
    v_mul_f32 v22, v18, v116
    v_fma_f32 v22, -v19, v117, v22
    v_mul_f32 v23, v18, v117
    v_fma_f32 v23, v19, v116, v23
    v_mul_f32 v24, v20, v122
    v_fma_f32 v24, -v21, v123, v24
    v_mul_f32 v25, v20, v123
    v_fma_f32 v25, v21, v122, v25
    v_mul_f32 v30, v112, v16
    v_mul_f32 v27, v113, v16
    v_exp_f32 v30, v30
    v_fract_f32 v27, v27
    v_cos_f32 v26, v27
    v_sin_f32 v27, v27
    s_nop 0
    v_mul_f32 v26, v26, v30
    v_mul_f32 v27, v27, v30
    v_mul_f32 v31, v118, v16
    v_mul_f32 v29, v119, v16
    v_exp_f32 v31, v31
    v_fract_f32 v29, v29
    v_cos_f32 v28, v29
    v_sin_f32 v29, v29
    s_nop 0
    v_mul_f32 v28, v28, v31
    v_mul_f32 v29, v29, v31
    v_mul_f32 v2, v114, v26
    v_fma_f32 v2, -v115, v27, v2
    v_mul_f32_e64 v4, -v114, v27
    v_fma_f32 v4, -v115, v26, v4
    v_mul_f32 v12, v120, v28
    v_fma_f32 v12, -v121, v29, v12
    v_mul_f32_e64 v13, -v120, v29
    v_fma_f32 v13, -v121, v28, v13
    v_cvt_pk_bf16_f32 v67, v18, v20
    v_lshlrev_b32 v30, 16, v67
    v_and_b32 v31, 0xffff0000, v67
    v_sub_f32 v30, v18, v30
    v_sub_f32 v31, v20, v31
    v_cvt_pk_bf16_f32 v71, v30, v31
    v_cvt_pk_bf16_f32 v75, v19, v21
    v_lshlrev_b32 v14, 16, v75
    v_and_b32 v15, 0xffff0000, v75
    v_sub_f32 v14, v19, v14
    v_sub_f32 v15, v21, v15
    v_cvt_pk_bf16_f32 v79, v14, v15
    v_cvt_pk_bf16_f32 v83, v22, v24
    v_lshlrev_b32 v30, 16, v83
    v_and_b32 v31, 0xffff0000, v83
    v_sub_f32 v30, v22, v30
    v_sub_f32 v31, v24, v31
    v_cvt_pk_bf16_f32 v87, v30, v31
    v_cvt_pk_bf16_f32 v91, v23, v25
    v_lshlrev_b32 v14, 16, v91
    v_and_b32 v15, 0xffff0000, v91
    v_sub_f32 v14, v23, v14
    v_sub_f32 v15, v25, v15
    v_cvt_pk_bf16_f32 v95, v14, v15
    v_cvt_pk_bf16_f32 v99, v2, v12
    v_lshlrev_b32 v30, 16, v99
    v_and_b32 v31, 0xffff0000, v99
    v_sub_f32 v30, v2, v30
    v_sub_f32 v31, v12, v31
    v_cvt_pk_bf16_f32 v103, v30, v31
    v_cvt_pk_bf16_f32 v107, v4, v13
    v_lshlrev_b32 v14, 16, v107
    v_and_b32 v15, 0xffff0000, v107
    v_sub_f32 v14, v4, v14
    v_sub_f32 v15, v13, v15
    v_cvt_pk_bf16_f32 v111, v14, v15
    v_add_u32 v8, 512, v8
    s_nop 0
    v_mfma_f32_32x32x16_bf16 v[32:47], v[68:71], v[96:99], v[32:47]
    v_mfma_f32_32x32x16_bf16 v[32:47], v[64:67], v[100:103], v[32:47]
    v_mfma_f32_32x32x16_bf16 v[32:47], v[64:67], v[96:99], v[32:47]
    v_mfma_f32_32x32x16_bf16 v[32:47], v[76:79], v[104:107], v[32:47]
    v_mfma_f32_32x32x16_bf16 v[32:47], v[72:75], v[108:111], v[32:47]
    v_mfma_f32_32x32x16_bf16 v[32:47], v[72:75], v[104:107], v[32:47]
    v_mfma_f32_32x32x16_bf16 v[48:63], v[84:87], v[96:99], v[48:63]
    v_mfma_f32_32x32x16_bf16 v[48:63], v[80:83], v[100:103], v[48:63]
    v_mfma_f32_32x32x16_bf16 v[48:63], v[80:83], v[96:99], v[48:63]
    v_mfma_f32_32x32x16_bf16 v[48:63], v[92:95], v[104:107], v[48:63]
    v_mfma_f32_32x32x16_bf16 v[48:63], v[88:91], v[108:111], v[48:63]
    v_mfma_f32_32x32x16_bf16 v[48:63], v[88:91], v[104:107], v[48:63]
    s_sub_u32 s35, s35, 1
    s_cmp_lg_u32 s35, 0
    s_cbranch_scc1 tail_kernel_b_kg
    s_barrier
    v_lshrrev_b32 v8, 4, v10
    v_add_u32 v8, v8, v10
    v_mul_u32_u24 v9, 136, v11
    v_add_u32 v8, v8, v9
    s_mul_i32 s31, s26, 8720
    s_add_u32 s31, s31, s29
    v_lshl_add_u32 v8, v8, 2, s31
    v_mov_b32 v9, s31
    s_nop 7
    ds_write_b32 v8, v32 offset:0
    ds_write_b32 v8, v33 offset:136
    ds_write_b32 v8, v34 offset:272
    ds_write_b32 v8, v35 offset:408
    ds_write_b32 v8, v36 offset:1088
    ds_write_b32 v8, v37 offset:1224
    ds_write_b32 v8, v38 offset:1360
    ds_write_b32 v8, v39 offset:1496
    ds_write_b32 v8, v40 offset:2176
    ds_write_b32 v8, v41 offset:2312
    ds_write_b32 v8, v42 offset:2448
    ds_write_b32 v8, v43 offset:2584
    ds_write_b32 v8, v44 offset:3264
    ds_write_b32 v8, v45 offset:3400
    ds_write_b32 v8, v46 offset:3536
    ds_write_b32 v8, v47 offset:3672
    ds_write_b32 v8, v48 offset:4352
    ds_write_b32 v8, v49 offset:4488
    ds_write_b32 v8, v50 offset:4624
    ds_write_b32 v8, v51 offset:4760
    ds_write_b32 v8, v52 offset:5440
    ds_write_b32 v8, v53 offset:5576
    ds_write_b32 v8, v54 offset:5712
    ds_write_b32 v8, v55 offset:5848
    ds_write_b32 v8, v56 offset:6528
    ds_write_b32 v8, v57 offset:6664
    ds_write_b32 v8, v58 offset:6800
    ds_write_b32 v8, v59 offset:6936
    ds_write_b32 v8, v60 offset:7616
    ds_write_b32 v8, v61 offset:7752
    ds_write_b32 v8, v62 offset:7888
    ds_write_b32 v8, v63 offset:8024
    ds_write_b32 v9, v7 offset:8704
    s_lshl_b32 s31, s26, 6
    v_add_u32 v8, s31, v1
    v_lshlrev_b32 v9, 3, v8
    v_add_u32 v64, 0, v9
    v_cvt_f32_u32 v64, v64
    v_cvt_pk_bf16_f32 v64, 0, v64
    v_cvt_u32_f32 v64, v64
    v_lshrrev_b32 v80, 4, v64
    v_add_u32 v64, v64, v80
    v_lshl_add_u32 v64, v64, 2, s29
    v_add_u32 v65, 1, v9
    v_cvt_f32_u32 v65, v65
    v_cvt_pk_bf16_f32 v65, 0, v65
    v_cvt_u32_f32 v65, v65
    v_lshrrev_b32 v80, 4, v65
    v_add_u32 v65, v65, v80
    v_lshl_add_u32 v65, v65, 2, s29
    v_add_u32 v66, 2, v9
    v_cvt_f32_u32 v66, v66
    v_cvt_pk_bf16_f32 v66, 0, v66
    v_cvt_u32_f32 v66, v66
    v_lshrrev_b32 v80, 4, v66
    v_add_u32 v66, v66, v80
    v_lshl_add_u32 v66, v66, 2, s29
    v_add_u32 v67, 3, v9
    v_cvt_f32_u32 v67, v67
    v_cvt_pk_bf16_f32 v67, 0, v67
    v_cvt_u32_f32 v67, v67
    v_lshrrev_b32 v80, 4, v67
    v_add_u32 v67, v67, v80
    v_lshl_add_u32 v67, v67, 2, s29
    v_add_u32 v68, 4, v9
    v_cvt_f32_u32 v68, v68
    v_cvt_pk_bf16_f32 v68, 0, v68
    v_cvt_u32_f32 v68, v68
    v_lshrrev_b32 v80, 4, v68
    v_add_u32 v68, v68, v80
    v_lshl_add_u32 v68, v68, 2, s29
    v_add_u32 v69, 5, v9
    v_cvt_f32_u32 v69, v69
    v_cvt_pk_bf16_f32 v69, 0, v69
    v_cvt_u32_f32 v69, v69
    v_lshrrev_b32 v80, 4, v69
    v_add_u32 v69, v69, v80
    v_lshl_add_u32 v69, v69, 2, s29
    v_add_u32 v70, 6, v9
    v_cvt_f32_u32 v70, v70
    v_cvt_pk_bf16_f32 v70, 0, v70
    v_cvt_u32_f32 v70, v70
    v_lshrrev_b32 v80, 4, v70
    v_add_u32 v70, v70, v80
    v_lshl_add_u32 v70, v70, 2, s29
    v_add_u32 v71, 7, v9
    v_cvt_f32_u32 v71, v71
    v_cvt_pk_bf16_f32 v71, 0, v71
    v_cvt_u32_f32 v71, v71
    v_lshrrev_b32 v80, 4, v71
    v_add_u32 v71, v71, v80
    v_lshl_add_u32 v71, v71, 2, s29
    s_waitcnt lgkmcnt(0)
    s_barrier
    ds_read_b32 v80, v64 offset:8720
    ds_read_b32 v88, v64 offset:17440
    ds_read_b32 v96, v64 offset:26160
    ds_read_b32 v64, v64
    ds_read_b32 v81, v65 offset:8720
    ds_read_b32 v89, v65 offset:17440
    ds_read_b32 v97, v65 offset:26160
    ds_read_b32 v65, v65
    ds_read_b32 v82, v66 offset:8720
    ds_read_b32 v90, v66 offset:17440
    ds_read_b32 v98, v66 offset:26160
    ds_read_b32 v66, v66
    s_waitcnt lgkmcnt(0)
    ds_read_b32 v83, v67 offset:8720
    ds_read_b32 v91, v67 offset:17440
    ds_read_b32 v99, v67 offset:26160
    ds_read_b32 v67, v67
    ds_read_b32 v84, v68 offset:8720
    ds_read_b32 v92, v68 offset:17440
    ds_read_b32 v100, v68 offset:26160
    ds_read_b32 v68, v68
    ds_read_b32 v85, v69 offset:8720
    ds_read_b32 v93, v69 offset:17440
    ds_read_b32 v101, v69 offset:26160
    ds_read_b32 v69, v69
    s_waitcnt lgkmcnt(0)
    ds_read_b32 v86, v70 offset:8720
    ds_read_b32 v94, v70 offset:17440
    ds_read_b32 v102, v70 offset:26160
    ds_read_b32 v70, v70
    ds_read_b32 v87, v71 offset:8720
    ds_read_b32 v95, v71 offset:17440
    ds_read_b32 v103, v71 offset:26160
    ds_read_b32 v71, v71
    s_waitcnt lgkmcnt(0)
    v_add_f32 v64, v64, v80
    v_add_f32 v88, v88, v96
    v_add_f32 v65, v65, v81
    v_add_f32 v89, v89, v97
    v_add_f32 v66, v66, v82
    v_add_f32 v90, v90, v98
    v_add_f32 v67, v67, v83
    v_add_f32 v91, v91, v99
    v_add_f32 v68, v68, v84
    v_add_f32 v92, v92, v100
    v_add_f32 v69, v69, v85
    v_add_f32 v93, v93, v101
    v_add_f32 v70, v70, v86
    v_add_f32 v94, v94, v102
    v_add_f32 v71, v71, v87
    v_add_f32 v95, v95, v103
    v_add_f32 v64, v64, v88
    v_add_f32 v65, v65, v89
    v_add_f32 v66, v66, v90
    v_add_f32 v67, v67, v91
    v_add_f32 v68, v68, v92
    v_add_f32 v69, v69, v93
    v_add_f32 v70, v70, v94
    v_add_f32 v71, v71, v95
    v_lshrrev_b32 v9, 2, v8
    v_add_u32 v9, 63, v9
    v_mul_u32_u24 v9, 144, v9
    v_and_b32 v12, 3, v8
    v_lshl_add_u32 v9, v12, 4, v9
    v_add_u32 v9, s29, v9
    v_cvt_pk_bf16_f32 v96, v71, v70
    v_lshlrev_b32 v30, 16, v96
    v_and_b32 v31, 0xffff0000, v96
    v_sub_f32 v30, v71, v30
    v_sub_f32 v31, v70, v31
    v_cvt_pk_bf16_f32 v100, v30, v31
    v_cvt_pk_bf16_f32 v97, v69, v68
    v_lshlrev_b32 v30, 16, v97
    v_and_b32 v31, 0xffff0000, v97
    v_sub_f32 v30, v69, v30
    v_sub_f32 v31, v68, v31
    v_cvt_pk_bf16_f32 v101, v30, v31
    v_cvt_pk_bf16_f32 v98, v67, v66
    v_lshlrev_b32 v30, 16, v98
    v_and_b32 v31, 0xffff0000, v98
    v_sub_f32 v30, v67, v30
    v_sub_f32 v31, v66, v31
    v_cvt_pk_bf16_f32 v102, v30, v31
    v_cvt_pk_bf16_f32 v99, v65, v64
    v_lshlrev_b32 v30, 16, v99
    v_and_b32 v31, 0xffff0000, v99
    v_sub_f32 v30, v65, v30
    v_sub_f32 v31, v64, v31
    v_cvt_pk_bf16_f32 v103, v30, v31
    v_mov_b32 v12, 0
    v_mov_b32 v13, 0
    v_mov_b32 v14, 0
    v_mov_b32 v15, 0
    s_barrier
    ds_write_b128 v9, v[96:99]
    ds_write_b128 v9, v[100:103] offset:64
    v_lshlrev_b32 v8, 4, v8
    v_add_u32 v8, s29, v8
    ds_write_b128 v8, v[12:15] offset:0
    ds_write_b128 v8, v[12:15] offset:4096
    v_cmp_gt_u32 vcc, 55, v1
    s_cmp_eq_u32 s26, 0
    s_cselect_b64 s[80:81], vcc, 0
    s_and_saveexec_b64 s[82:83], s[80:81]
    s_cbranch_execz tail_kernel_b_z1
    ds_write_b128 v8, v[12:15] offset:8192
tail_kernel_b_z1:
    s_mov_b64 exec, s[82:83]
    v_lshrrev_b32 v8, 3, v10
    v_mul_u32_u24 v8, 4416, v8
    v_and_b32 v9, 7, v10
    v_lshl_add_u32 v8, v9, 4, v8
    v_add_u32 v8, s29, v8
    s_cmp_eq_u32 s26, 1
    s_cbranch_scc0 tail_kernel_b_z2
    ds_write_b128 v8, v[12:15] offset:18432
    s_waitcnt lgkmcnt(0)
tail_kernel_b_z2:
    s_barrier
    v_lshlrev_b32 v8, 1, v0
    v_add_u32 v9, 36864, v8
    s_waitcnt vmcnt(0)
    ds_write_b16 v8, v124 offset:18560
    ds_write_b16_d16_hi v9, v124 offset:18560
    ds_write_b16 v8, v124 offset:22974
    ds_write_b16_d16_hi v9, v124 offset:22974
    ds_write_b16 v8, v124 offset:27388
    ds_write_b16_d16_hi v9, v124 offset:27388
    ds_write_b16 v8, v124 offset:31802
    ds_write_b16_d16_hi v9, v124 offset:31802
    ds_write_b16 v8, v125 offset:19584
    ds_write_b16_d16_hi v9, v125 offset:19584
    ds_write_b16 v8, v125 offset:23998
    ds_write_b16_d16_hi v9, v125 offset:23998
    ds_write_b16 v8, v125 offset:28412
    ds_write_b16_d16_hi v9, v125 offset:28412
    ds_write_b16 v8, v125 offset:32826
    ds_write_b16_d16_hi v9, v125 offset:32826
    ds_write_b16 v8, v126 offset:20608
    ds_write_b16_d16_hi v9, v126 offset:20608
    ds_write_b16 v8, v126 offset:25022
    ds_write_b16_d16_hi v9, v126 offset:25022
    ds_write_b16 v8, v126 offset:29436
    ds_write_b16_d16_hi v9, v126 offset:29436
    ds_write_b16 v8, v126 offset:33850
    ds_write_b16_d16_hi v9, v126 offset:33850
    ds_write_b16 v8, v127 offset:21632
    ds_write_b16_d16_hi v9, v127 offset:21632
    ds_write_b16 v8, v127 offset:26046
    ds_write_b16_d16_hi v9, v127 offset:26046
    ds_write_b16 v8, v127 offset:30460
    ds_write_b16_d16_hi v9, v127 offset:30460
    ds_write_b16 v8, v127 offset:34874
    ds_write_b16_d16_hi v9, v127 offset:34874
    v_add_u32 v8, 57, v10
    v_and_b32 v9, 3, v8
    v_lshrrev_b32 v8, 2, v8
    v_lshlrev_b32 v12, 1, v11
    v_sub_u32 v8, v8, v12
    v_lshlrev_b32 v8, 3, v8
    v_mul_u32_u24 v9, 4416, v9
    v_add_u32 v8, v8, v9
    s_lshl_b32 s31, s26, 9
    s_add_u32 s31, s31, s29
    s_add_u32 s31, s31, 18400
    v_add_u32 v8, s31, v8
    v_mul_u32_u24 v9, 144, v10
    v_lshl_add_u32 v9, v11, 4, v9
    s_mul_i32 s31, s26, 1152
    s_sub_u32 s31, s29, s31
    s_add_u32 s31, s31, 8928
    v_add_u32 v9, s31, v9
    v_mov_b32 v32, 0
    v_mov_b32 v33, 0
    v_mov_b32 v34, 0
    v_mov_b32 v35, 0
    v_mov_b32 v36, 0
    v_mov_b32 v37, 0
    v_mov_b32 v38, 0
    v_mov_b32 v39, 0
    v_mov_b32 v40, 0
    v_mov_b32 v41, 0
    v_mov_b32 v42, 0
    v_mov_b32 v43, 0
    v_mov_b32 v44, 0
    v_mov_b32 v45, 0
    v_mov_b32 v46, 0
    v_mov_b32 v47, 0
    v_mov_b32 v48, 0
    v_mov_b32 v49, 0
    v_mov_b32 v50, 0
    v_mov_b32 v51, 0
    v_mov_b32 v52, 0
    v_mov_b32 v53, 0
    v_mov_b32 v54, 0
    v_mov_b32 v55, 0
    v_mov_b32 v56, 0
    v_mov_b32 v57, 0
    v_mov_b32 v58, 0
    v_mov_b32 v59, 0
    v_mov_b32 v60, 0
    v_mov_b32 v61, 0
    v_mov_b32 v62, 0
    v_mov_b32 v63, 0
    s_mov_b32 s35, 8
    s_waitcnt lgkmcnt(0)
    s_barrier
    ds_read_b64 v[64:65], v8 offset:32
    ds_read_b64 v[66:67], v8 offset:40
    ds_read_b64 v[68:69], v8 offset:2080
    ds_read_b64 v[70:71], v8 offset:2088
    ds_read_b128 v[72:75], v9 offset:144
    ds_read_b128 v[76:79], v9 offset:208
    ds_read_b128 v[80:83], v9 offset:4752
    ds_read_b128 v[84:87], v9 offset:4816
tail_kernel_b_c1:
    ds_read_b64 v[88:89], v8 offset:0
    ds_read_b64 v[90:91], v8 offset:8
    ds_read_b64 v[92:93], v8 offset:2048
    ds_read_b64 v[94:95], v8 offset:2056
    ds_read_b128 v[96:99], v9 offset:176
    ds_read_b128 v[100:103], v9 offset:240
    ds_read_b128 v[104:107], v9 offset:4784
    ds_read_b128 v[108:111], v9 offset:4848
    s_waitcnt lgkmcnt(8)
    v_mfma_f32_32x32x16_bf16 v[32:47], v[64:67], v[72:75], v[32:47]
    v_mfma_f32_32x32x16_bf16 v[48:63], v[64:67], v[80:83], v[48:63]
    v_mfma_f32_32x32x16_bf16 v[32:47], v[64:67], v[76:79], v[32:47]
    v_mfma_f32_32x32x16_bf16 v[48:63], v[64:67], v[84:87], v[48:63]
    v_mfma_f32_32x32x16_bf16 v[48:63], v[68:71], v[72:75], v[48:63]
    v_mfma_f32_32x32x16_bf16 v[48:63], v[68:71], v[76:79], v[48:63]
    ds_read_b64 v[64:65], v8 offset:96
    ds_read_b64 v[66:67], v8 offset:104
    ds_read_b64 v[68:69], v8 offset:2144
    ds_read_b64 v[70:71], v8 offset:2152
    ds_read_b128 v[72:75], v9 offset:0
    ds_read_b128 v[76:79], v9 offset:64
    ds_read_b128 v[80:83], v9 offset:4608
    ds_read_b128 v[84:87], v9 offset:4672
    v_add_u32 v8, 64, v8
    v_subrev_u32 v9, 144, v9
    s_waitcnt lgkmcnt(8)
    v_mfma_f32_32x32x16_bf16 v[32:47], v[88:91], v[96:99], v[32:47]
    v_mfma_f32_32x32x16_bf16 v[48:63], v[88:91], v[104:107], v[48:63]
    v_mfma_f32_32x32x16_bf16 v[32:47], v[88:91], v[100:103], v[32:47]
    v_mfma_f32_32x32x16_bf16 v[48:63], v[88:91], v[108:111], v[48:63]
    v_mfma_f32_32x32x16_bf16 v[48:63], v[92:95], v[96:99], v[48:63]
    v_mfma_f32_32x32x16_bf16 v[48:63], v[92:95], v[100:103], v[48:63]
    s_sub_u32 s35, s35, 1
    s_cmp_lg_u32 s35, 0
    s_cbranch_scc1 tail_kernel_b_c1
    s_waitcnt lgkmcnt(0)
    s_nop 15
    s_barrier
    s_mul_i32 s31, s26, 9216
    s_add_u32 s31, s31, s29
    v_mul_u32_u24 v8, 144, v10
    v_lshl_add_u32 v8, v11, 4, v8
    v_add_u32 v8, s31, v8
    ds_write_b128 v8, v[32:35] offset:0
    ds_write_b128 v8, v[36:39] offset:32
    ds_write_b128 v8, v[40:43] offset:64
    ds_write_b128 v8, v[44:47] offset:96
    ds_write_b128 v8, v[48:51] offset:4608
    ds_write_b128 v8, v[52:55] offset:4640
    ds_write_b128 v8, v[56:59] offset:4672
    ds_write_b128 v8, v[60:63] offset:4704
    v_lshrrev_b32 v8, 5, v0
    v_mul_u32_u24 v8, 144, v8
    v_lshl_add_u32 v8, v10, 2, v8
    v_add_u32 v9, 36864, v8
    v_lshlrev_b32 v12, 16, v6
    v_and_b32 v13, 0xffff0000, v6
    v_lshlrev_b32 v3, 11, v0
    s_add_u32 s30, s30, 1024
    s_waitcnt lgkmcnt(0)
    s_barrier
    ds_read_b32 v64, v8 offset:0
    ds_read_b32 v68, v9 offset:0
    ds_read_b32 v65, v8 offset:9216
    ds_read_b32 v69, v9 offset:9216
    ds_read_b32 v66, v8 offset:18432
    ds_read_b32 v70, v9 offset:18432
    ds_read_b32 v67, v8 offset:27648
    ds_read_b32 v71, v9 offset:27648
    ds_read_b32 v72, v8 offset:2304
    ds_read_b32 v76, v9 offset:2304
    ds_read_b32 v73, v8 offset:11520
    ds_read_b32 v77, v9 offset:11520
    ds_read_b32 v74, v8 offset:20736
    ds_read_b32 v78, v9 offset:20736
    ds_read_b32 v75, v8 offset:29952
    ds_read_b32 v79, v9 offset:29952
    s_waitcnt lgkmcnt(0)
    ds_read_b32 v80, v8 offset:4608
    ds_read_b32 v84, v9 offset:4608
    ds_read_b32 v81, v8 offset:13824
    ds_read_b32 v85, v9 offset:13824
    ds_read_b32 v82, v8 offset:23040
    ds_read_b32 v86, v9 offset:23040
    ds_read_b32 v83, v8 offset:32256
    ds_read_b32 v87, v9 offset:32256
    ds_read_b32 v88, v8 offset:6912
    ds_read_b32 v92, v9 offset:6912
    ds_read_b32 v89, v8 offset:16128
    ds_read_b32 v93, v9 offset:16128
    ds_read_b32 v90, v8 offset:25344
    ds_read_b32 v94, v9 offset:25344
    ds_read_b32 v91, v8 offset:34560
    ds_read_b32 v95, v9 offset:34560
    s_waitcnt lgkmcnt(0)
    v_add_f32 v64, v64, v65
    v_add_f32 v66, v66, v67
    v_add_f32 v64, v64, v66
    v_cvt_pk_bf16_f32 v64, 0, v64
    v_add_f32 v68, v68, v69
    v_add_f32 v70, v70, v71
    v_add_f32 v68, v68, v70
    v_cvt_pk_bf16_f32 v68, 0, v68
    v_lshlrev_b32 v14, 16, v124
    v_and_b32 v15, 0xffff0000, v124
    v_mul_f32 v14, v14, v12
    v_mul_f32 v15, v15, v13
    v_cvt_pk_bf16_f32 v14, 0, v14
    v_cvt_pk_bf16_f32 v15, 0, v15
    v_add_f32 v14, v14, v64
    v_add_f32 v15, v15, v68
    v_cvt_pk_bf16_f32 v64, v14, v15
    s_add_u32 s31, s30, 0
    buffer_store_dword v64, v3, s[76:79], s31 offen
    v_add_f32 v72, v72, v73
    v_add_f32 v74, v74, v75
    v_add_f32 v72, v72, v74
    v_cvt_pk_bf16_f32 v72, 0, v72
    v_add_f32 v76, v76, v77
    v_add_f32 v78, v78, v79
    v_add_f32 v76, v76, v78
    v_cvt_pk_bf16_f32 v76, 0, v76
    v_lshlrev_b32 v14, 16, v125
    v_and_b32 v15, 0xffff0000, v125
    v_mul_f32 v14, v14, v12
    v_mul_f32 v15, v15, v13
    v_cvt_pk_bf16_f32 v14, 0, v14
    v_cvt_pk_bf16_f32 v15, 0, v15
    v_add_f32 v14, v14, v72
    v_add_f32 v15, v15, v76
    v_cvt_pk_bf16_f32 v72, v14, v15
    s_add_u32 s31, s30, 1048576
    buffer_store_dword v72, v3, s[76:79], s31 offen
    v_add_f32 v80, v80, v81
    v_add_f32 v82, v82, v83
    v_add_f32 v80, v80, v82
    v_cvt_pk_bf16_f32 v80, 0, v80
    v_add_f32 v84, v84, v85
    v_add_f32 v86, v86, v87
    v_add_f32 v84, v84, v86
    v_cvt_pk_bf16_f32 v84, 0, v84
    v_lshlrev_b32 v14, 16, v126
    v_and_b32 v15, 0xffff0000, v126
    v_mul_f32 v14, v14, v12
    v_mul_f32 v15, v15, v13
    v_cvt_pk_bf16_f32 v14, 0, v14
    v_cvt_pk_bf16_f32 v15, 0, v15
    v_add_f32 v14, v14, v80
    v_add_f32 v15, v15, v84
    v_cvt_pk_bf16_f32 v80, v14, v15
    s_add_u32 s31, s30, 2097152
    buffer_store_dword v80, v3, s[76:79], s31 offen
    v_add_f32 v88, v88, v89
    v_add_f32 v90, v90, v91
    v_add_f32 v88, v88, v90
    v_cvt_pk_bf16_f32 v88, 0, v88
    v_add_f32 v92, v92, v93
    v_add_f32 v94, v94, v95
    v_add_f32 v92, v92, v94
    v_cvt_pk_bf16_f32 v92, 0, v92
    v_lshlrev_b32 v14, 16, v127
    v_and_b32 v15, 0xffff0000, v127
    v_mul_f32 v14, v14, v12
    v_mul_f32 v15, v15, v13
    v_cvt_pk_bf16_f32 v14, 0, v14
    v_cvt_pk_bf16_f32 v15, 0, v15
    v_add_f32 v14, v14, v88
    v_add_f32 v15, v15, v92
    v_cvt_pk_bf16_f32 v88, v14, v15
    s_add_u32 s31, s30, 3145728
    buffer_store_dword v88, v3, s[76:79], s31 offen
tail_kernel_done:
    s_endpgm
code_end:
    s_endpgm
.section .rodata,"a"
.p2align 6
.amdhsa_kernel qkv_kernel
  .amdhsa_next_free_vgpr 256
  .amdhsa_next_free_sgpr 102
  .amdhsa_accum_offset 128
  .amdhsa_group_segment_fixed_size 0
  .amdhsa_kernarg_size 144
  .amdhsa_user_sgpr_count 2
  .amdhsa_user_sgpr_kernarg_segment_ptr 1
  .amdhsa_system_sgpr_workgroup_id_x 1
  .amdhsa_float_denorm_mode_32 3
.end_amdhsa_kernel

.p2align 6
.amdhsa_kernel attn_kernel
  .amdhsa_next_free_vgpr 256
  .amdhsa_next_free_sgpr 102
  .amdhsa_accum_offset 224
  .amdhsa_group_segment_fixed_size 0
  .amdhsa_kernarg_size 144
  .amdhsa_user_sgpr_count 2
  .amdhsa_user_sgpr_kernarg_segment_ptr 1
  .amdhsa_system_sgpr_workgroup_id_x 1
  .amdhsa_float_denorm_mode_32 3
.end_amdhsa_kernel

.p2align 6
.amdhsa_kernel tail_kernel
  .amdhsa_next_free_vgpr 128
  .amdhsa_next_free_sgpr 102
  .amdhsa_accum_offset 128
  .amdhsa_group_segment_fixed_size 0
  .amdhsa_kernarg_size 144
  .amdhsa_user_sgpr_count 2
  .amdhsa_user_sgpr_kernarg_segment_ptr 1
  .amdhsa_system_sgpr_workgroup_id_x 1
  .amdhsa_float_denorm_mode_32 3
.end_amdhsa_kernel
```
